```python
import torch

def _softmax(x, axis=-1):
    return torch.softmax(x, dim=axis)
def _gelu(x):
    return torch.nn.functional.gelu(x, approximate="tanh")
def _silu(x):
    return torch.nn.functional.silu(x)
def _sigmoid(x):
    return torch.sigmoid(x)
def _layernorm(x, axis=-1, eps=1e-5):
    m = x.mean(dim=axis, keepdim=True)
    v = x.var(dim=axis, keepdim=True, unbiased=False)
    return (x - m) / torch.sqrt(v + eps)
def _scatter_add(tgt, idx, src, axis=0):
    return tgt.clone().index_add_(axis, idx, src)
def _segment_sum(src, seg, n):
    out = torch.zeros((n,) + src.shape[1:], dtype=src.dtype)
    return out.index_add_(0, seg, src)
def _pad(x, pw):
    flat = tuple(v for pair in reversed(pw) for v in pair)
    return torch.nn.functional.pad(x, flat)

kernel_name = 'parallel_sum__mha_block_cached__glu_gated_bilinear__decode'

def setup_inputs():

    _w = (lambda a: (lambda t: t.to(torch.bfloat16) if t.is_floating_point() else t)(torch.as_tensor(a)))
    def _A_setup():
        B, Sq, D = 8, 1, 1024
        H, Sk, Dh = 32, 4096, 128
        return {
            "x": _w((lambda *s: torch.randn(*s, dtype=torch.bfloat16) * 0.05)(B, Sq, D)),
            "k_cache": _w((lambda *s: torch.randn(*s, dtype=torch.bfloat16) * 1.6)(B, H, Sk, Dh)),
            "v_cache": _w((lambda *s: torch.randn(*s, dtype=torch.bfloat16) * 0.8)(B, H, Sk, Dh)),
            "wq": _w((lambda *s: torch.randn(*s, dtype=torch.bfloat16) * 1.6)(D, H * Dh) * (D ** -0.5)),
            "wo": _w((lambda *s: torch.randn(*s, dtype=torch.bfloat16) * 0.8)(H * Dh, D) * ((H * Dh) ** -0.5)),
        }
    _A_in = _A_setup()

    def _B_setup():
        B, S, D, F = 8, 1, 1024, 3584
        return {
            "x": _w((lambda *s: torch.randn(*s, dtype=torch.bfloat16) * 0.05)(B, S, D)),
            "w_gate": _w((lambda *s: torch.randn(*s, dtype=torch.bfloat16) * 0.4)(D, F) * (D ** -0.5)),
            "w_up": _w((lambda *s: torch.randn(*s, dtype=torch.bfloat16) * 0.4)(D, F) * (D ** -0.5)),
            "w_down": _w((lambda *s: torch.randn(*s, dtype=torch.bfloat16) * 0.4)(F, D) * (F ** -0.5)),
        }
    _B_in = _B_setup()

    return {
        "A_x": _A_in["x"],
        "A_k_cache": _A_in["k_cache"],
        "A_v_cache": _A_in["v_cache"],
        "A_wq": _A_in["wq"],
        "A_wo": _A_in["wo"],
        "B_x": _B_in["x"],
        "B_w_gate": _B_in["w_gate"],
        "B_w_up": _B_in["w_up"],
        "B_w_down": _B_in["w_down"],
    }

def reference(A_x, A_k_cache, A_v_cache, A_wq, A_wo, B_x, B_w_gate, B_w_up, B_w_down):
    def _A_ref(x, k_cache, v_cache, wq, wo):
        B, Sq, D = x.shape
        H, Dh = 32, 128
        q = (lambda x, *d: x.permute(*d))((x @ wq).reshape(B, Sq, H, Dh), 0, 2, 1, 3)
        scores = torch.einsum("bhqd,bhkd->bhqk", q, k_cache) * (Dh ** -0.5)
        p = _softmax(scores, axis=-1)
        o = torch.einsum("bhqk,bhkd->bhqd", p, v_cache)
        return (lambda x, *d: x.permute(*d))(o, 0, 2, 1, 3).reshape(B, Sq, H * Dh) @ wo

    def _B_ref(x, w_gate, w_up, w_down):
        g = torch.einsum("bsd,df->bsf", x, w_gate)
        u = torch.einsum("bsd,df->bsf", x, w_up)
        h = g * u
        return torch.einsum("bsf,fd->bsd", h, w_down)

    x = A_x
    xn = _layernorm(x, axis=-1)
    return x + _A_ref(xn, A_k_cache, A_v_cache, A_wq, A_wo) + _B_ref(xn, B_w_gate, B_w_up, B_w_down)
```

```asm
; @launch grid=(256,1,1) block=(512,1,1) lds=141952
.amdgcn_target "amdgcn-amd-amdhsa--gfx950"
.text
.globl parallel_sum__mha_block_cached__glu_gated_bilinear__decode_kernel
.p2align 8
.type parallel_sum__mha_block_cached__glu_gated_bilinear__decode_kernel,@function
parallel_sum__mha_block_cached__glu_gated_bilinear__decode_kernel:
    s_cmp_ge_u32 s2, 256
    s_cbranch_scc1 L_end
    s_load_dwordx16 s[4:19], s[0:1], 0
    s_load_dwordx8 s[20:27], s[0:1], 64
    v_cmp_gt_u32 vcc, 32, v0
    s_cbranch_vccz L_nozero
    v_lshlrev_b32 v1, 2, v0
    v_and_b32 v1, 127, v1
    v_add_u32 v1, 0x229a0, v1
    v_mov_b32 v2, 0
    ds_write_b32 v1, v2
    s_waitcnt lgkmcnt(0)
L_nozero:
    v_and_b32 v1, 63, v0
    v_lshrrev_b32 v2, 6, v0
    s_lshr_b32 s44, s2, 5
    s_and_b32 s45, s2, 31
    v_readfirstlane_b32 s3, v2
    s_lshl_b32 s46, s45, 3
    s_add_u32 s46, s46, s44
    s_lshr_b32 s47, s46, 2
    s_and_b32 s48, s46, 3
    s_cmp_ge_u32 s3, 4
    s_cbranch_scc1 L_aux
    v_mov_b32 v21, 0x229a0
    v_and_b32 v2, 3, v1
    v_lshlrev_b32 v2, 4, v2
    v_bfe_u32 v17, v1, 2, 2
    v_lshl_add_u32 v2, v17, 8, v2
    v_lshrrev_b32 v17, 4, v1
    v_lshl_add_u32 v2, v17, 6, v2
    s_lshl_b32 s49, s3, 12
    s_lshl_b32 s53, s3, 12
    v_add_u32 v2, s53, v2
    v_add_u32 v3, 0x4000, v2
    v_add_u32 v4, 0x8000, v2
    v_add_u32 v5, 0xc000, v2
    s_lshl_b32 s50, s2, 20
    s_mov_b32 s51, 0
    s_mov_b32 s55, 0x10000
    s_waitcnt lgkmcnt(0)
    s_add_u32 s40, s6, s50
    s_addc_u32 s41, s7, 0
    s_mov_b32 s42, 0x100000
    s_mov_b32 s43, 0x20000
    buffer_load_dwordx4 v[64:67], v2, s[40:43], s51 offen offset:0 nt
    buffer_load_dwordx4 v[68:71], v2, s[40:43], s51 offen offset:1024 nt
    buffer_load_dwordx4 v[72:75], v2, s[40:43], s51 offen offset:2048 nt
    buffer_load_dwordx4 v[76:79], v2, s[40:43], s51 offen offset:3072 nt
    buffer_load_dwordx4 v[80:83], v3, s[40:43], s51 offen offset:0 nt
    s_barrier
    v_lshlrev_b32 v6, 4, v1
    v_add_u32 v6, s53, v6
    v_add_u32 v7, 0x4000, v6
    v_add_u32 v8, 0x8000, v6
    v_add_u32 v9, 0xc000, v6
    s_cmp_ge_u32 s46, 224
    s_cbranch_scc1 L_s_nodma
    v_lshrrev_b32 v17, 3, v1
    v_mul_u32_u24 v10, 7168, v17
    v_and_b32 v17, 7, v1
    v_lshl_add_u32 v10, v17, 4, v10
    s_mul_i32 s52, s48, 1835008
    s_lshl_b32 s53, s47, 7
    s_add_u32 s52, s52, s53
    s_sub_u32 s53, 7340032, s52
    s_add_u32 s28, s16, s52
    s_addc_u32 s29, s17, 0
    s_mov_b32 s30, s53
    s_mov_b32 s31, 0x20000
    s_add_u32 s32, s18, s52
    s_addc_u32 s33, s19, 0
    s_mov_b32 s34, s53
    s_mov_b32 s35, 0x20000
    s_lshl_b32 s56, s3, 13
    s_add_u32 m0, s56, 0x8000
    s_mul_i32 s54, s3, 458752
    s_waitcnt vmcnt(4)
    buffer_load_dwordx4 v10, s[28:31], s54 offen nt lds
    s_add_u32 m0, m0, 0x400
    s_add_u32 s54, s54, 57344
    s_waitcnt vmcnt(4)
    buffer_load_dwordx4 v10, s[28:31], s54 offen nt lds
    s_add_u32 m0, m0, 0x400
    s_add_u32 s54, s54, 57344
    s_waitcnt vmcnt(4)
    buffer_load_dwordx4 v10, s[28:31], s54 offen nt lds
    s_add_u32 m0, m0, 0x400
    s_add_u32 s54, s54, 57344
    s_waitcnt vmcnt(4)
    buffer_load_dwordx4 v10, s[28:31], s54 offen nt lds
    s_add_u32 m0, m0, 0x400
    s_add_u32 s54, s54, 57344
    s_waitcnt vmcnt(4)
    buffer_load_dwordx4 v10, s[28:31], s54 offen nt lds
    s_add_u32 m0, m0, 0x400
    s_add_u32 s54, s54, 57344
    s_waitcnt vmcnt(4)
    buffer_load_dwordx4 v10, s[28:31], s54 offen nt lds
    s_add_u32 m0, m0, 0x400
    s_add_u32 s54, s54, 57344
    s_waitcnt vmcnt(4)
    buffer_load_dwordx4 v10, s[28:31], s54 offen nt lds
    s_add_u32 m0, m0, 0x400
    s_add_u32 s54, s54, 57344
    s_waitcnt vmcnt(4)
    buffer_load_dwordx4 v10, s[28:31], s54 offen nt lds
    s_add_u32 m0, s56, 0x10000
    s_mul_i32 s54, s3, 458752
    s_waitcnt vmcnt(4)
    buffer_load_dwordx4 v10, s[32:35], s54 offen nt lds
    s_add_u32 m0, m0, 0x400
    s_add_u32 s54, s54, 57344
    s_waitcnt vmcnt(4)
    buffer_load_dwordx4 v10, s[32:35], s54 offen nt lds
    s_add_u32 m0, m0, 0x400
    s_add_u32 s54, s54, 57344
    s_waitcnt vmcnt(4)
    buffer_load_dwordx4 v10, s[32:35], s54 offen nt lds
    s_add_u32 m0, m0, 0x400
    s_add_u32 s54, s54, 57344
    s_waitcnt vmcnt(4)
    buffer_load_dwordx4 v10, s[32:35], s54 offen nt lds
    s_add_u32 m0, m0, 0x400
    s_add_u32 s54, s54, 57344
    s_waitcnt vmcnt(4)
    buffer_load_dwordx4 v10, s[32:35], s54 offen nt lds
    s_add_u32 m0, m0, 0x400
    s_add_u32 s54, s54, 57344
    s_waitcnt vmcnt(4)
    buffer_load_dwordx4 v10, s[32:35], s54 offen nt lds
    s_add_u32 m0, m0, 0x400
    s_add_u32 s54, s54, 57344
    s_waitcnt vmcnt(4)
    buffer_load_dwordx4 v10, s[32:35], s54 offen nt lds
    s_add_u32 m0, m0, 0x400
    s_add_u32 s54, s54, 57344
    s_waitcnt vmcnt(4)
    buffer_load_dwordx4 v10, s[32:35], s54 offen nt lds
L_s_nodma:
    v_lshrrev_b32 v17, 4, v1
    v_lshlrev_b32 v11, 11, v17
    v_and_b32 v17, 15, v1
    v_lshl_add_u32 v11, v17, 4, v11
    s_mul_i32 s52, s45, 229376
    s_lshl_b32 s53, s44, 8
    s_add_u32 s52, s52, s53
    s_sub_u32 s53, 7340032, s52
    s_add_u32 s36, s20, s52
    s_addc_u32 s37, s21, 0
    s_mov_b32 s38, s53
    s_mov_b32 s39, 0x20000
    s_mul_i32 s56, s3, 7168
    s_add_u32 m0, s56, 0x18000
    s_mul_i32 s54, s3, 57344
    s_waitcnt vmcnt(4)
    buffer_load_dwordx4 v11, s[36:39], s54 offen nt lds
    s_add_u32 m0, m0, 0x400
    s_add_u32 s54, s54, 8192
    s_waitcnt vmcnt(4)
    buffer_load_dwordx4 v11, s[36:39], s54 offen nt lds
    s_add_u32 m0, m0, 0x400
    s_add_u32 s54, s54, 8192
    s_waitcnt vmcnt(4)
    buffer_load_dwordx4 v11, s[36:39], s54 offen nt lds
    s_add_u32 m0, m0, 0x400
    s_add_u32 s54, s54, 8192
    s_waitcnt vmcnt(4)
    buffer_load_dwordx4 v11, s[36:39], s54 offen nt lds
    s_add_u32 m0, m0, 0x400
    s_add_u32 s54, s54, 8192
    s_waitcnt vmcnt(4)
    buffer_load_dwordx4 v11, s[36:39], s54 offen nt lds
    s_add_u32 m0, m0, 0x400
    s_add_u32 s54, s54, 8192
    s_waitcnt vmcnt(4)
    buffer_load_dwordx4 v11, s[36:39], s54 offen nt lds
    s_add_u32 m0, m0, 0x400
    s_add_u32 s54, s54, 8192
    s_waitcnt vmcnt(4)
    buffer_load_dwordx4 v11, s[36:39], s54 offen nt lds
    s_mov_b32 s56, 0x22222222
    s_mov_b32 s57, 0x22222222
    s_mov_b32 s58, 0x44444444
    s_mov_b32 s59, 0x44444444
    s_mov_b32 s60, 0x88888888
    s_mov_b32 s61, 0x88888888
    v_and_b32 v17, 1, v1
    v_cmp_eq_u32 vcc, 1, v17
    v_mov_b32 v15, 0xffff
    v_mov_b32 v16, 0xffff0000
    v_cndmask_b32 v15, v15, v16, vcc
    v_bfe_u32 v17, v1, 1, 3
    v_cmp_eq_u32 vcc, 0, v17
    s_nop 1
    v_cndmask_b32 v48, 0, v15, vcc
    v_cmp_eq_u32 vcc, 1, v17
    s_nop 1
    v_cndmask_b32 v49, 0, v15, vcc
    v_cmp_eq_u32 vcc, 2, v17
    s_nop 1
    v_cndmask_b32 v50, 0, v15, vcc
    v_cmp_eq_u32 vcc, 3, v17
    s_nop 1
    v_cndmask_b32 v51, 0, v15, vcc
    v_lshlrev_b32 v12, 2, v1
    v_add_u32 v12, s49, v12
    v_mov_b32 v13, 0xff800000
    v_mov_b32 v56, 0
    v_mov_b32 v57, 0
    v_mov_b32 v58, 0
    v_mov_b32 v59, 0
    v_mov_b32 v10, 0
    s_lshl_b32 s54, s3, 2
    v_add_u32 v11, s54, v21
    v_and_b32 v15, 3, v1
    v_lshrrev_b32 v17, 4, v1
    v_lshl_add_u32 v15, v17, 2, v15
    v_lshlrev_b32 v15, 4, v15
    v_add_u32 v15, 0x21800, v15
    v_bfe_u32 v17, v1, 2, 2
    v_mov_b32 v16, 0x229e0
    v_cmp_eq_u32 vcc, 0, v17
    s_nop 1
    v_cndmask_b32 v52, v16, v15, vcc
    v_cmp_eq_u32 vcc, 1, v17
    s_nop 1
    v_cndmask_b32 v53, v16, v15, vcc
    v_cmp_eq_u32 vcc, 2, v17
    s_nop 1
    v_cndmask_b32 v54, v16, v15, vcc
    v_cmp_eq_u32 vcc, 3, v17
    s_nop 1
    v_cndmask_b32 v55, v16, v15, vcc
    s_waitcnt vmcnt(4)
    buffer_load_dwordx4 v[84:87], v3, s[40:43], s51 offen offset:1024 nt
    s_waitcnt vmcnt(4)
    buffer_load_dwordx4 v[88:91], v3, s[40:43], s51 offen offset:2048 nt
    s_waitcnt vmcnt(4)
    buffer_load_dwordx4 v[92:95], v3, s[40:43], s51 offen offset:3072 nt
    s_waitcnt vmcnt(4)
    buffer_load_dwordx4 v[96:99], v4, s[40:43], s51 offen offset:0 nt
    s_waitcnt vmcnt(4)
    buffer_load_dwordx4 v[100:103], v4, s[40:43], s51 offen offset:1024 nt
    s_waitcnt vmcnt(4)
    buffer_load_dwordx4 v[104:107], v4, s[40:43], s51 offen offset:2048 nt
    s_waitcnt vmcnt(4)
    buffer_load_dwordx4 v[108:111], v4, s[40:43], s51 offen offset:3072 nt
    s_waitcnt vmcnt(4)
    buffer_load_dwordx4 v[112:115], v5, s[40:43], s51 offen offset:0 nt
    s_waitcnt vmcnt(4)
    buffer_load_dwordx4 v[116:119], v5, s[40:43], s51 offen offset:1024 nt
    s_waitcnt vmcnt(4)
    buffer_load_dwordx4 v[120:123], v5, s[40:43], s51 offen offset:2048 nt
    s_waitcnt vmcnt(4)
    buffer_load_dwordx4 v[124:127], v5, s[40:43], s51 offen offset:3072 nt
    s_waitcnt vmcnt(4)
    buffer_load_dwordx4 v[128:131], v2, s[40:43], s55 offen offset:0 nt
    ds_write_b32 v11, v21 offset:48
    s_waitcnt vmcnt(4)
    buffer_load_dwordx4 v[132:135], v2, s[40:43], s55 offen offset:1024 nt
    s_waitcnt vmcnt(4)
    buffer_load_dwordx4 v[136:139], v2, s[40:43], s55 offen offset:2048 nt
    s_waitcnt vmcnt(4)
    buffer_load_dwordx4 v[140:143], v2, s[40:43], s55 offen offset:3072 nt
    s_waitcnt vmcnt(4)
    buffer_load_dwordx4 v[144:147], v3, s[40:43], s55 offen offset:0 nt
    s_waitcnt vmcnt(4)
    buffer_load_dwordx4 v[148:151], v3, s[40:43], s55 offen offset:1024 nt
    s_waitcnt vmcnt(4)
    buffer_load_dwordx4 v[152:155], v3, s[40:43], s55 offen offset:2048 nt
    s_waitcnt vmcnt(4)
    buffer_load_dwordx4 v[156:159], v3, s[40:43], s55 offen offset:3072 nt
    s_waitcnt vmcnt(4)
    buffer_load_dwordx4 v[160:163], v4, s[40:43], s55 offen offset:0 nt
    s_waitcnt vmcnt(4)
    buffer_load_dwordx4 v[164:167], v4, s[40:43], s55 offen offset:1024 nt
    s_waitcnt vmcnt(4)
    buffer_load_dwordx4 v[168:171], v4, s[40:43], s55 offen offset:2048 nt
    s_waitcnt vmcnt(4)
    buffer_load_dwordx4 v[172:175], v4, s[40:43], s55 offen offset:3072 nt
    s_waitcnt vmcnt(4)
    buffer_load_dwordx4 v[176:179], v5, s[40:43], s55 offen offset:0 nt
    s_waitcnt vmcnt(4)
    buffer_load_dwordx4 v[180:183], v5, s[40:43], s55 offen offset:1024 nt
    s_waitcnt vmcnt(4)
    buffer_load_dwordx4 v[184:187], v5, s[40:43], s55 offen offset:2048 nt
    s_waitcnt vmcnt(4)
    buffer_load_dwordx4 v[188:191], v5, s[40:43], s55 offen offset:3072 nt
    s_barrier
    ds_read_b128 v[32:35], v52
    ds_read_b128 v[36:39], v53
    ds_read_b128 v[40:43], v54
    ds_read_b128 v[44:47], v55
    s_waitcnt lgkmcnt(0)
    s_mov_b32 s52, 0
L_kloop:
    s_add_u32 s51, s51, 0x20000
    s_add_u32 s55, s55, 0x20000
    s_cmp_lg_u32 s52, 14
    s_cbranch_scc1 L_k_go
    s_add_u32 s40, s8, s50
    s_addc_u32 s41, s9, 0
    s_mov_b32 s51, 0
    s_mov_b32 s55, 0x10000
    v_mov_b32 v2, v6
    v_mov_b32 v3, v7
    v_mov_b32 v4, v8
    v_mov_b32 v5, v9
L_k_go:
    s_waitcnt lgkmcnt(0)
    v_mov_b32 v60, s52
    ds_write_b32 v11, v60 offset:32
    v_readfirstlane_b32 s54, v10
    s_nop 0
    s_cmp_lt_u32 s52, s54
    s_cselect_b64 vcc, -1, 0
    v_mfma_f32_16x16x32_bf16 v[24:27], v[64:67], v[32:35], 0
    s_cbranch_vccnz L_m_1
    s_waitcnt vmcnt(4)
L_m_1:
    s_waitcnt vmcnt(6)
    buffer_load_dwordx4 v[64:67], v2, s[40:43], s51 offen offset:0 nt
    v_mfma_f32_16x16x32_bf16 v[24:27], v[68:71], v[36:39], v[24:27]
    s_cbranch_vccnz L_m_3
    s_waitcnt vmcnt(4)
L_m_3:
    s_waitcnt vmcnt(6)
    buffer_load_dwordx4 v[68:71], v2, s[40:43], s51 offen offset:1024 nt
    v_mfma_f32_16x16x32_bf16 v[24:27], v[72:75], v[40:43], v[24:27]
    s_cbranch_vccnz L_m_5
    s_waitcnt vmcnt(4)
L_m_5:
    s_waitcnt vmcnt(6)
    buffer_load_dwordx4 v[72:75], v2, s[40:43], s51 offen offset:2048 nt
    v_mfma_f32_16x16x32_bf16 v[24:27], v[76:79], v[44:47], v[24:27]
    s_cbranch_vccnz L_m_7
    s_waitcnt vmcnt(4)
L_m_7:
    s_waitcnt vmcnt(6)
    buffer_load_dwordx4 v[76:79], v2, s[40:43], s51 offen offset:3072 nt
    v_mfma_f32_16x16x32_bf16 v[28:31], v[80:83], v[32:35], 0
    s_cbranch_vccnz L_m_9
    s_waitcnt vmcnt(4)
L_m_9:
    s_waitcnt vmcnt(6)
    buffer_load_dwordx4 v[80:83], v3, s[40:43], s51 offen offset:0 nt
    v_mfma_f32_16x16x32_bf16 v[28:31], v[84:87], v[36:39], v[28:31]
    s_cbranch_vccnz L_m_11
    s_waitcnt vmcnt(4)
L_m_11:
    s_waitcnt vmcnt(6)
    buffer_load_dwordx4 v[84:87], v3, s[40:43], s51 offen offset:1024 nt
    v_mfma_f32_16x16x32_bf16 v[28:31], v[88:91], v[40:43], v[28:31]
    v_add_f32_dpp v15, v25, v26 quad_perm:[1,1,1,1] row_mask:0xf bank_mask:0xf
    v_add_f32_dpp v16, v27, v24 quad_perm:[3,3,3,3] row_mask:0xf bank_mask:0xf
    s_nop 0
    v_add_f32_dpp v14, v15, v16 quad_perm:[2,2,2,2] row_mask:0xf bank_mask:0xf
    s_cbranch_vccnz L_m_13
    s_waitcnt vmcnt(4)
L_m_13:
    s_waitcnt vmcnt(6)
    buffer_load_dwordx4 v[88:91], v3, s[40:43], s51 offen offset:2048 nt
    v_mfma_f32_16x16x32_bf16 v[28:31], v[92:95], v[44:47], v[28:31]
    s_cbranch_vccnz L_m_15
    s_waitcnt vmcnt(4)
L_m_15:
    s_waitcnt vmcnt(6)
    buffer_load_dwordx4 v[92:95], v3, s[40:43], s51 offen offset:3072 nt
    v_mfma_f32_16x16x32_bf16 v[24:27], v[96:99], v[32:35], 0
    s_cbranch_vccnz L_m_17
    s_waitcnt vmcnt(4)
L_m_17:
    s_waitcnt vmcnt(6)
    buffer_load_dwordx4 v[96:99], v4, s[40:43], s51 offen offset:0 nt
    v_mfma_f32_16x16x32_bf16 v[24:27], v[100:103], v[36:39], v[24:27]
    s_cbranch_vccnz L_m_19
    s_waitcnt vmcnt(4)
L_m_19:
    s_waitcnt vmcnt(6)
    buffer_load_dwordx4 v[100:103], v4, s[40:43], s51 offen offset:1024 nt
    v_mfma_f32_16x16x32_bf16 v[24:27], v[104:107], v[40:43], v[24:27]
    v_add_f32_dpp v15, v30, v31 quad_perm:[2,2,2,2] row_mask:0xf bank_mask:0xf
    v_add_f32_dpp v16, v28, v29 quad_perm:[0,0,0,0] row_mask:0xf bank_mask:0xf
    s_nop 0
    v_add_f32_dpp v16, v15, v16 quad_perm:[3,3,3,3] row_mask:0xf bank_mask:0xf
    v_cndmask_b32 v14, v14, v16, s[56:57]
    s_cbranch_vccnz L_m_21
    s_waitcnt vmcnt(4)
L_m_21:
    s_waitcnt vmcnt(6)
    buffer_load_dwordx4 v[104:107], v4, s[40:43], s51 offen offset:2048 nt
    v_mfma_f32_16x16x32_bf16 v[24:27], v[108:111], v[44:47], v[24:27]
    s_cbranch_vccnz L_m_23
    s_waitcnt vmcnt(4)
L_m_23:
    s_waitcnt vmcnt(6)
    buffer_load_dwordx4 v[108:111], v4, s[40:43], s51 offen offset:3072 nt
    v_mfma_f32_16x16x32_bf16 v[28:31], v[112:115], v[32:35], 0
    s_cbranch_vccnz L_m_25
    s_waitcnt vmcnt(4)
L_m_25:
    s_waitcnt vmcnt(6)
    buffer_load_dwordx4 v[112:115], v5, s[40:43], s51 offen offset:0 nt
    v_mfma_f32_16x16x32_bf16 v[28:31], v[116:119], v[36:39], v[28:31]
    s_cbranch_vccnz L_m_27
    s_waitcnt vmcnt(4)
L_m_27:
    s_waitcnt vmcnt(6)
    buffer_load_dwordx4 v[116:119], v5, s[40:43], s51 offen offset:1024 nt
    v_mfma_f32_16x16x32_bf16 v[28:31], v[120:123], v[40:43], v[28:31]
    v_add_f32_dpp v15, v27, v24 quad_perm:[3,3,3,3] row_mask:0xf bank_mask:0xf
    v_add_f32_dpp v16, v25, v26 quad_perm:[1,1,1,1] row_mask:0xf bank_mask:0xf
    s_nop 0
    v_add_f32_dpp v16, v15, v16 quad_perm:[0,0,0,0] row_mask:0xf bank_mask:0xf
    v_cndmask_b32 v14, v14, v16, s[58:59]
    s_cbranch_vccnz L_m_29
    s_waitcnt vmcnt(4)
L_m_29:
    s_waitcnt vmcnt(6)
    buffer_load_dwordx4 v[120:123], v5, s[40:43], s51 offen offset:2048 nt
    v_mfma_f32_16x16x32_bf16 v[28:31], v[124:127], v[44:47], v[28:31]
    ds_read_b32 v10, v21 offset:20
    s_cbranch_vccnz L_m_31
    s_waitcnt vmcnt(4)
L_m_31:
    s_waitcnt vmcnt(6)
    buffer_load_dwordx4 v[124:127], v5, s[40:43], s51 offen offset:3072 nt
    s_nop 5
    v_add_f32_dpp v15, v28, v29 quad_perm:[0,0,0,0] row_mask:0xf bank_mask:0xf
    v_add_f32_dpp v16, v30, v31 quad_perm:[2,2,2,2] row_mask:0xf bank_mask:0xf
    s_nop 0
    v_add_f32_dpp v16, v15, v16 quad_perm:[1,1,1,1] row_mask:0xf bank_mask:0xf
    v_cndmask_b32 v14, v14, v16, s[60:61]
    v_cvt_pk_bf16_f32 v14, v14, v14
    v_lshlrev_b32 v14, 16, v14
    v_mul_f32 v14, 0x3db504f3, v14
    v_cvt_pk_bf16_f32 v14, v14, v14
    v_and_b32 v14, 0xffff0000, v14
    v_max_f32 v13, v13, v14
    ds_write_b32 v12, v14
    v_add_u32 v12, 0x100, v12
    s_add_u32 s52, s52, 1
    s_waitcnt lgkmcnt(0)
    v_mov_b32 v60, s52
    ds_write_b32 v11, v60 offset:32
    v_readfirstlane_b32 s54, v10
    s_nop 0
    s_cmp_lt_u32 s52, s54
    s_cselect_b64 vcc, -1, 0
    v_mfma_f32_16x16x32_bf16 v[24:27], v[128:131], v[32:35], 0
    s_cbranch_vccnz L_m_33
    s_waitcnt vmcnt(4)
L_m_33:
    s_waitcnt vmcnt(6)
    buffer_load_dwordx4 v[128:131], v2, s[40:43], s55 offen offset:0 nt
    v_mfma_f32_16x16x32_bf16 v[24:27], v[132:135], v[36:39], v[24:27]
    s_cbranch_vccnz L_m_35
    s_waitcnt vmcnt(4)
L_m_35:
    s_waitcnt vmcnt(6)
    buffer_load_dwordx4 v[132:135], v2, s[40:43], s55 offen offset:1024 nt
    v_mfma_f32_16x16x32_bf16 v[24:27], v[136:139], v[40:43], v[24:27]
    s_cbranch_vccnz L_m_37
    s_waitcnt vmcnt(4)
L_m_37:
    s_waitcnt vmcnt(6)
    buffer_load_dwordx4 v[136:139], v2, s[40:43], s55 offen offset:2048 nt
    v_mfma_f32_16x16x32_bf16 v[24:27], v[140:143], v[44:47], v[24:27]
    s_cbranch_vccnz L_m_39
    s_waitcnt vmcnt(4)
L_m_39:
    s_waitcnt vmcnt(6)
    buffer_load_dwordx4 v[140:143], v2, s[40:43], s55 offen offset:3072 nt
    v_mfma_f32_16x16x32_bf16 v[28:31], v[144:147], v[32:35], 0
    s_cbranch_vccnz L_m_41
    s_waitcnt vmcnt(4)
L_m_41:
    s_waitcnt vmcnt(6)
    buffer_load_dwordx4 v[144:147], v3, s[40:43], s55 offen offset:0 nt
    v_mfma_f32_16x16x32_bf16 v[28:31], v[148:151], v[36:39], v[28:31]
    s_cbranch_vccnz L_m_43
    s_waitcnt vmcnt(4)
L_m_43:
    s_waitcnt vmcnt(6)
    buffer_load_dwordx4 v[148:151], v3, s[40:43], s55 offen offset:1024 nt
    v_mfma_f32_16x16x32_bf16 v[28:31], v[152:155], v[40:43], v[28:31]
    v_add_f32_dpp v15, v25, v26 quad_perm:[1,1,1,1] row_mask:0xf bank_mask:0xf
    v_add_f32_dpp v16, v27, v24 quad_perm:[3,3,3,3] row_mask:0xf bank_mask:0xf
    s_nop 0
    v_add_f32_dpp v14, v15, v16 quad_perm:[2,2,2,2] row_mask:0xf bank_mask:0xf
    s_cbranch_vccnz L_m_45
    s_waitcnt vmcnt(4)
L_m_45:
    s_waitcnt vmcnt(6)
    buffer_load_dwordx4 v[152:155], v3, s[40:43], s55 offen offset:2048 nt
    v_mfma_f32_16x16x32_bf16 v[28:31], v[156:159], v[44:47], v[28:31]
    s_cbranch_vccnz L_m_47
    s_waitcnt vmcnt(4)
L_m_47:
    s_waitcnt vmcnt(6)
    buffer_load_dwordx4 v[156:159], v3, s[40:43], s55 offen offset:3072 nt
    v_mfma_f32_16x16x32_bf16 v[24:27], v[160:163], v[32:35], 0
    s_cbranch_vccnz L_m_49
    s_waitcnt vmcnt(4)
L_m_49:
    s_waitcnt vmcnt(6)
    buffer_load_dwordx4 v[160:163], v4, s[40:43], s55 offen offset:0 nt
    v_mfma_f32_16x16x32_bf16 v[24:27], v[164:167], v[36:39], v[24:27]
    s_cbranch_vccnz L_m_51
    s_waitcnt vmcnt(4)
L_m_51:
    s_waitcnt vmcnt(6)
    buffer_load_dwordx4 v[164:167], v4, s[40:43], s55 offen offset:1024 nt
    v_mfma_f32_16x16x32_bf16 v[24:27], v[168:171], v[40:43], v[24:27]
    v_add_f32_dpp v15, v30, v31 quad_perm:[2,2,2,2] row_mask:0xf bank_mask:0xf
    v_add_f32_dpp v16, v28, v29 quad_perm:[0,0,0,0] row_mask:0xf bank_mask:0xf
    s_nop 0
    v_add_f32_dpp v16, v15, v16 quad_perm:[3,3,3,3] row_mask:0xf bank_mask:0xf
    v_cndmask_b32 v14, v14, v16, s[56:57]
    s_cbranch_vccnz L_m_53
    s_waitcnt vmcnt(4)
L_m_53:
    s_waitcnt vmcnt(6)
    buffer_load_dwordx4 v[168:171], v4, s[40:43], s55 offen offset:2048 nt
    v_mfma_f32_16x16x32_bf16 v[24:27], v[172:175], v[44:47], v[24:27]
    s_cbranch_vccnz L_m_55
    s_waitcnt vmcnt(4)
L_m_55:
    s_waitcnt vmcnt(6)
    buffer_load_dwordx4 v[172:175], v4, s[40:43], s55 offen offset:3072 nt
    v_mfma_f32_16x16x32_bf16 v[28:31], v[176:179], v[32:35], 0
    s_cbranch_vccnz L_m_57
    s_waitcnt vmcnt(4)
L_m_57:
    s_waitcnt vmcnt(6)
    buffer_load_dwordx4 v[176:179], v5, s[40:43], s55 offen offset:0 nt
    v_mfma_f32_16x16x32_bf16 v[28:31], v[180:183], v[36:39], v[28:31]
    s_cbranch_vccnz L_m_59
    s_waitcnt vmcnt(4)
L_m_59:
    s_waitcnt vmcnt(6)
    buffer_load_dwordx4 v[180:183], v5, s[40:43], s55 offen offset:1024 nt
    v_mfma_f32_16x16x32_bf16 v[28:31], v[184:187], v[40:43], v[28:31]
    v_add_f32_dpp v15, v27, v24 quad_perm:[3,3,3,3] row_mask:0xf bank_mask:0xf
    v_add_f32_dpp v16, v25, v26 quad_perm:[1,1,1,1] row_mask:0xf bank_mask:0xf
    s_nop 0
    v_add_f32_dpp v16, v15, v16 quad_perm:[0,0,0,0] row_mask:0xf bank_mask:0xf
    v_cndmask_b32 v14, v14, v16, s[58:59]
    s_cbranch_vccnz L_m_61
    s_waitcnt vmcnt(4)
L_m_61:
    s_waitcnt vmcnt(6)
    buffer_load_dwordx4 v[184:187], v5, s[40:43], s55 offen offset:2048 nt
    v_mfma_f32_16x16x32_bf16 v[28:31], v[188:191], v[44:47], v[28:31]
    ds_read_b32 v10, v21 offset:20
    s_cbranch_vccnz L_m_63
    s_waitcnt vmcnt(4)
L_m_63:
    s_waitcnt vmcnt(6)
    buffer_load_dwordx4 v[188:191], v5, s[40:43], s55 offen offset:3072 nt
    s_nop 5
    v_add_f32_dpp v15, v28, v29 quad_perm:[0,0,0,0] row_mask:0xf bank_mask:0xf
    v_add_f32_dpp v16, v30, v31 quad_perm:[2,2,2,2] row_mask:0xf bank_mask:0xf
    s_nop 0
    v_add_f32_dpp v16, v15, v16 quad_perm:[1,1,1,1] row_mask:0xf bank_mask:0xf
    v_cndmask_b32 v14, v14, v16, s[60:61]
    v_cvt_pk_bf16_f32 v14, v14, v14
    v_lshlrev_b32 v14, 16, v14
    v_mul_f32 v14, 0x3db504f3, v14
    v_cvt_pk_bf16_f32 v14, v14, v14
    v_and_b32 v14, 0xffff0000, v14
    v_max_f32 v13, v13, v14
    ds_write_b32 v12, v14
    v_add_u32 v12, 0x100, v12
    s_add_u32 s52, s52, 1
    s_cmp_lt_u32 s52, 16
    s_cbranch_scc1 L_kloop
    v_add_u32 v12, -4096, v12
    ds_read_b32 v19, v12
    s_nop 1
    v_max_f32_dpp v13, v13, v13 row_ror:8 row_mask:0xf bank_mask:0xf
    s_nop 1
    v_max_f32_dpp v13, v13, v13 row_ror:4 row_mask:0xf bank_mask:0xf
    s_nop 1
    v_max_f32_dpp v13, v13, v13 row_ror:2 row_mask:0xf bank_mask:0xf
    s_nop 1
    v_max_f32_dpp v13, v13, v13 row_ror:1 row_mask:0xf bank_mask:0xf
    v_mov_b32 v17, v13
    s_nop 1
    v_permlane16_swap_b32 v13, v17
    s_nop 0
    v_max_f32 v13, v13, v17
    v_mov_b32 v17, v13
    s_nop 1
    v_permlane32_swap_b32 v13, v17
    s_nop 0
    v_max_f32 v13, v13, v17
    s_mov_b32 s53, 0x3fb8aa3b
    v_mul_f32 v18, 0xbfb8aa3b, v13
    s_lshl_b32 s54, s3, 2
    s_add_u32 s54, s54, 0x22900
    v_mov_b32 v17, s54
    ds_write_b32 v17, v13
    s_mov_b64 exec, 1
    v_mov_b32 v17, 1
    ds_add_u32 v21, v17 offset:28
    s_mov_b64 exec, -1
    s_mov_b32 s56, 64
    v_mov_b32 v61, 0
    v_mov_b32 v62, 64
L_vloop:
    s_add_u32 s51, s51, 0x20000
    s_add_u32 s55, s55, 0x20000
    v_add_u32 v12, 0x100, v12
    s_waitcnt lgkmcnt(0)
    v_fma_f32 v17, v19, s53, v18
    ds_read_b32 v19, v12
    v_exp_f32 v17, v17
    v_mov_b32 v60, s52
    ds_write_b32 v11, v60 offset:32
    v_readfirstlane_b32 s54, v10
    s_nop 0
    s_cmp_lt_u32 s52, s54
    s_cselect_b64 vcc, -1, 0
    v_cvt_pk_bf16_f32 v20, v17, v17
    s_nop 1
    v_and_b32_dpp v52, v20, v48 row_newbcast:0 row_mask:0xf bank_mask:0xf
    v_and_b32_dpp v53, v20, v49 row_newbcast:0 row_mask:0xf bank_mask:0xf
    v_and_b32_dpp v54, v20, v50 row_newbcast:0 row_mask:0xf bank_mask:0xf
    v_and_b32_dpp v55, v20, v51 row_newbcast:0 row_mask:0xf bank_mask:0xf
    s_nop 1
    v_mfma_f32_16x16x32_bf16 v[56:59], v[52:55], v[64:67], v[56:59]
    s_cbranch_vccnz L_m_65
    s_waitcnt vmcnt(4)
L_m_65:
    s_waitcnt vmcnt(6)
    buffer_load_dwordx4 v[64:67], v2, s[40:43], s51 offen offset:0 nt
    v_and_b32_dpp v52, v20, v48 row_newbcast:4 row_mask:0xf bank_mask:0xf
    v_and_b32_dpp v53, v20, v49 row_newbcast:4 row_mask:0xf bank_mask:0xf
    v_and_b32_dpp v54, v20, v50 row_newbcast:4 row_mask:0xf bank_mask:0xf
    v_and_b32_dpp v55, v20, v51 row_newbcast:4 row_mask:0xf bank_mask:0xf
    s_nop 1
    v_mfma_f32_16x16x32_bf16 v[56:59], v[52:55], v[68:71], v[56:59]
    s_cbranch_vccnz L_m_67
    s_waitcnt vmcnt(4)
L_m_67:
    s_waitcnt vmcnt(6)
    buffer_load_dwordx4 v[68:71], v2, s[40:43], s51 offen offset:1024 nt
    v_and_b32_dpp v52, v20, v48 row_newbcast:8 row_mask:0xf bank_mask:0xf
    v_and_b32_dpp v53, v20, v49 row_newbcast:8 row_mask:0xf bank_mask:0xf
    v_and_b32_dpp v54, v20, v50 row_newbcast:8 row_mask:0xf bank_mask:0xf
    v_and_b32_dpp v55, v20, v51 row_newbcast:8 row_mask:0xf bank_mask:0xf
    s_nop 1
    v_mfma_f32_16x16x32_bf16 v[56:59], v[52:55], v[72:75], v[56:59]
    s_cbranch_vccnz L_m_69
    s_waitcnt vmcnt(4)
L_m_69:
    s_waitcnt vmcnt(6)
    buffer_load_dwordx4 v[72:75], v2, s[40:43], s51 offen offset:2048 nt
    v_and_b32_dpp v52, v20, v48 row_newbcast:12 row_mask:0xf bank_mask:0xf
    v_and_b32_dpp v53, v20, v49 row_newbcast:12 row_mask:0xf bank_mask:0xf
    v_and_b32_dpp v54, v20, v50 row_newbcast:12 row_mask:0xf bank_mask:0xf
    v_and_b32_dpp v55, v20, v51 row_newbcast:12 row_mask:0xf bank_mask:0xf
    s_nop 1
    v_mfma_f32_16x16x32_bf16 v[56:59], v[52:55], v[76:79], v[56:59]
    s_cbranch_vccnz L_m_71
    s_waitcnt vmcnt(4)
L_m_71:
    s_waitcnt vmcnt(6)
    buffer_load_dwordx4 v[76:79], v2, s[40:43], s51 offen offset:3072 nt
    v_and_b32_dpp v52, v20, v48 row_newbcast:1 row_mask:0xf bank_mask:0xf
    v_and_b32_dpp v53, v20, v49 row_newbcast:1 row_mask:0xf bank_mask:0xf
    v_and_b32_dpp v54, v20, v50 row_newbcast:1 row_mask:0xf bank_mask:0xf
    v_and_b32_dpp v55, v20, v51 row_newbcast:1 row_mask:0xf bank_mask:0xf
    s_nop 1
    v_mfma_f32_16x16x32_bf16 v[56:59], v[52:55], v[80:83], v[56:59]
    s_cbranch_vccnz L_m_73
    s_waitcnt vmcnt(4)
L_m_73:
    s_waitcnt vmcnt(6)
    buffer_load_dwordx4 v[80:83], v3, s[40:43], s51 offen offset:0 nt
    v_and_b32_dpp v52, v20, v48 row_newbcast:5 row_mask:0xf bank_mask:0xf
    v_and_b32_dpp v53, v20, v49 row_newbcast:5 row_mask:0xf bank_mask:0xf
    v_and_b32_dpp v54, v20, v50 row_newbcast:5 row_mask:0xf bank_mask:0xf
    v_and_b32_dpp v55, v20, v51 row_newbcast:5 row_mask:0xf bank_mask:0xf
    s_nop 1
    v_mfma_f32_16x16x32_bf16 v[56:59], v[52:55], v[84:87], v[56:59]
    s_cbranch_vccnz L_m_75
    s_waitcnt vmcnt(4)
L_m_75:
    s_waitcnt vmcnt(6)
    buffer_load_dwordx4 v[84:87], v3, s[40:43], s51 offen offset:1024 nt
    v_and_b32_dpp v52, v20, v48 row_newbcast:9 row_mask:0xf bank_mask:0xf
    v_and_b32_dpp v53, v20, v49 row_newbcast:9 row_mask:0xf bank_mask:0xf
    v_and_b32_dpp v54, v20, v50 row_newbcast:9 row_mask:0xf bank_mask:0xf
    v_and_b32_dpp v55, v20, v51 row_newbcast:9 row_mask:0xf bank_mask:0xf
    s_nop 1
    v_mfma_f32_16x16x32_bf16 v[56:59], v[52:55], v[88:91], v[56:59]
    s_cbranch_vccnz L_m_77
    s_waitcnt vmcnt(4)
L_m_77:
    s_waitcnt vmcnt(6)
    buffer_load_dwordx4 v[88:91], v3, s[40:43], s51 offen offset:2048 nt
    v_and_b32_dpp v52, v20, v48 row_newbcast:13 row_mask:0xf bank_mask:0xf
    v_and_b32_dpp v53, v20, v49 row_newbcast:13 row_mask:0xf bank_mask:0xf
    v_and_b32_dpp v54, v20, v50 row_newbcast:13 row_mask:0xf bank_mask:0xf
    v_and_b32_dpp v55, v20, v51 row_newbcast:13 row_mask:0xf bank_mask:0xf
    s_nop 1
    v_mfma_f32_16x16x32_bf16 v[56:59], v[52:55], v[92:95], v[56:59]
    s_cbranch_vccnz L_m_79
    s_waitcnt vmcnt(4)
L_m_79:
    s_waitcnt vmcnt(6)
    buffer_load_dwordx4 v[92:95], v3, s[40:43], s51 offen offset:3072 nt
    v_and_b32_dpp v52, v20, v48 row_newbcast:2 row_mask:0xf bank_mask:0xf
    v_and_b32_dpp v53, v20, v49 row_newbcast:2 row_mask:0xf bank_mask:0xf
    v_and_b32_dpp v54, v20, v50 row_newbcast:2 row_mask:0xf bank_mask:0xf
    v_and_b32_dpp v55, v20, v51 row_newbcast:2 row_mask:0xf bank_mask:0xf
    s_nop 1
    v_mfma_f32_16x16x32_bf16 v[56:59], v[52:55], v[96:99], v[56:59]
    s_cbranch_vccnz L_m_81
    s_waitcnt vmcnt(4)
L_m_81:
    s_waitcnt vmcnt(6)
    buffer_load_dwordx4 v[96:99], v4, s[40:43], s51 offen offset:0 nt
    v_and_b32_dpp v52, v20, v48 row_newbcast:6 row_mask:0xf bank_mask:0xf
    v_and_b32_dpp v53, v20, v49 row_newbcast:6 row_mask:0xf bank_mask:0xf
    v_and_b32_dpp v54, v20, v50 row_newbcast:6 row_mask:0xf bank_mask:0xf
    v_and_b32_dpp v55, v20, v51 row_newbcast:6 row_mask:0xf bank_mask:0xf
    s_nop 1
    v_mfma_f32_16x16x32_bf16 v[56:59], v[52:55], v[100:103], v[56:59]
    s_cbranch_vccnz L_m_83
    s_waitcnt vmcnt(4)
L_m_83:
    s_waitcnt vmcnt(6)
    buffer_load_dwordx4 v[100:103], v4, s[40:43], s51 offen offset:1024 nt
    v_and_b32_dpp v52, v20, v48 row_newbcast:10 row_mask:0xf bank_mask:0xf
    v_and_b32_dpp v53, v20, v49 row_newbcast:10 row_mask:0xf bank_mask:0xf
    v_and_b32_dpp v54, v20, v50 row_newbcast:10 row_mask:0xf bank_mask:0xf
    v_and_b32_dpp v55, v20, v51 row_newbcast:10 row_mask:0xf bank_mask:0xf
    s_nop 1
    v_mfma_f32_16x16x32_bf16 v[56:59], v[52:55], v[104:107], v[56:59]
    s_cbranch_vccnz L_m_85
    s_waitcnt vmcnt(4)
L_m_85:
    s_waitcnt vmcnt(6)
    buffer_load_dwordx4 v[104:107], v4, s[40:43], s51 offen offset:2048 nt
    v_and_b32_dpp v52, v20, v48 row_newbcast:14 row_mask:0xf bank_mask:0xf
    v_and_b32_dpp v53, v20, v49 row_newbcast:14 row_mask:0xf bank_mask:0xf
    v_and_b32_dpp v54, v20, v50 row_newbcast:14 row_mask:0xf bank_mask:0xf
    v_and_b32_dpp v55, v20, v51 row_newbcast:14 row_mask:0xf bank_mask:0xf
    s_nop 1
    v_mfma_f32_16x16x32_bf16 v[56:59], v[52:55], v[108:111], v[56:59]
    s_cbranch_vccnz L_m_87
    s_waitcnt vmcnt(4)
L_m_87:
    s_waitcnt vmcnt(6)
    buffer_load_dwordx4 v[108:111], v4, s[40:43], s51 offen offset:3072 nt
    v_and_b32_dpp v52, v20, v48 row_newbcast:3 row_mask:0xf bank_mask:0xf
    v_and_b32_dpp v53, v20, v49 row_newbcast:3 row_mask:0xf bank_mask:0xf
    v_and_b32_dpp v54, v20, v50 row_newbcast:3 row_mask:0xf bank_mask:0xf
    v_and_b32_dpp v55, v20, v51 row_newbcast:3 row_mask:0xf bank_mask:0xf
    s_nop 1
    v_mfma_f32_16x16x32_bf16 v[56:59], v[52:55], v[112:115], v[56:59]
    s_cbranch_vccnz L_m_89
    s_waitcnt vmcnt(4)
L_m_89:
    s_waitcnt vmcnt(6)
    buffer_load_dwordx4 v[112:115], v5, s[40:43], s51 offen offset:0 nt
    v_and_b32_dpp v52, v20, v48 row_newbcast:7 row_mask:0xf bank_mask:0xf
    v_and_b32_dpp v53, v20, v49 row_newbcast:7 row_mask:0xf bank_mask:0xf
    v_and_b32_dpp v54, v20, v50 row_newbcast:7 row_mask:0xf bank_mask:0xf
    v_and_b32_dpp v55, v20, v51 row_newbcast:7 row_mask:0xf bank_mask:0xf
    s_nop 1
    v_mfma_f32_16x16x32_bf16 v[56:59], v[52:55], v[116:119], v[56:59]
    s_cbranch_vccnz L_m_91
    s_waitcnt vmcnt(4)
L_m_91:
    s_waitcnt vmcnt(6)
    buffer_load_dwordx4 v[116:119], v5, s[40:43], s51 offen offset:1024 nt
    v_and_b32_dpp v52, v20, v48 row_newbcast:11 row_mask:0xf bank_mask:0xf
    v_and_b32_dpp v53, v20, v49 row_newbcast:11 row_mask:0xf bank_mask:0xf
    v_and_b32_dpp v54, v20, v50 row_newbcast:11 row_mask:0xf bank_mask:0xf
    v_and_b32_dpp v55, v20, v51 row_newbcast:11 row_mask:0xf bank_mask:0xf
    s_nop 1
    v_mfma_f32_16x16x32_bf16 v[56:59], v[52:55], v[120:123], v[56:59]
    s_cbranch_vccnz L_m_93
    s_waitcnt vmcnt(4)
L_m_93:
    s_waitcnt vmcnt(6)
    buffer_load_dwordx4 v[120:123], v5, s[40:43], s51 offen offset:2048 nt
    v_and_b32_dpp v52, v20, v48 row_newbcast:15 row_mask:0xf bank_mask:0xf
    v_and_b32_dpp v53, v20, v49 row_newbcast:15 row_mask:0xf bank_mask:0xf
    v_and_b32_dpp v54, v20, v50 row_newbcast:15 row_mask:0xf bank_mask:0xf
    v_and_b32_dpp v55, v20, v51 row_newbcast:15 row_mask:0xf bank_mask:0xf
    s_nop 1
    v_mfma_f32_16x16x32_bf16 v[56:59], v[52:55], v[124:127], v[56:59]
    ds_read_b32 v10, v21 offset:20
    s_cbranch_vccnz L_m_95
    s_waitcnt vmcnt(4)
L_m_95:
    s_waitcnt vmcnt(6)
    buffer_load_dwordx4 v[124:127], v5, s[40:43], s51 offen offset:3072 nt
    s_add_u32 s52, s52, 1
    v_add_u32 v12, 0x100, v12
    s_waitcnt lgkmcnt(0)
    v_fma_f32 v17, v19, s53, v18
    ds_read_b32 v19, v12
    v_exp_f32 v17, v17
    v_mov_b32 v60, s52
    ds_write_b32 v11, v60 offset:32
    v_readfirstlane_b32 s54, v10
    s_nop 0
    s_cmp_lt_u32 s52, s54
    s_cselect_b64 vcc, -1, 0
    v_cvt_pk_bf16_f32 v20, v17, v17
    s_nop 1
    v_and_b32_dpp v52, v20, v48 row_newbcast:0 row_mask:0xf bank_mask:0xf
    v_and_b32_dpp v53, v20, v49 row_newbcast:0 row_mask:0xf bank_mask:0xf
    v_and_b32_dpp v54, v20, v50 row_newbcast:0 row_mask:0xf bank_mask:0xf
    v_and_b32_dpp v55, v20, v51 row_newbcast:0 row_mask:0xf bank_mask:0xf
    s_nop 1
    v_mfma_f32_16x16x32_bf16 v[56:59], v[52:55], v[128:131], v[56:59]
    s_cbranch_vccnz L_m_97
    s_waitcnt vmcnt(4)
L_m_97:
    s_waitcnt vmcnt(6)
    buffer_load_dwordx4 v[128:131], v2, s[40:43], s55 offen offset:0 nt
    v_and_b32_dpp v52, v20, v48 row_newbcast:4 row_mask:0xf bank_mask:0xf
    v_and_b32_dpp v53, v20, v49 row_newbcast:4 row_mask:0xf bank_mask:0xf
    v_and_b32_dpp v54, v20, v50 row_newbcast:4 row_mask:0xf bank_mask:0xf
    v_and_b32_dpp v55, v20, v51 row_newbcast:4 row_mask:0xf bank_mask:0xf
    s_nop 1
    v_mfma_f32_16x16x32_bf16 v[56:59], v[52:55], v[132:135], v[56:59]
    s_cbranch_vccnz L_m_99
    s_waitcnt vmcnt(4)
L_m_99:
    s_waitcnt vmcnt(6)
    buffer_load_dwordx4 v[132:135], v2, s[40:43], s55 offen offset:1024 nt
    v_and_b32_dpp v52, v20, v48 row_newbcast:8 row_mask:0xf bank_mask:0xf
    v_and_b32_dpp v53, v20, v49 row_newbcast:8 row_mask:0xf bank_mask:0xf
    v_and_b32_dpp v54, v20, v50 row_newbcast:8 row_mask:0xf bank_mask:0xf
    v_and_b32_dpp v55, v20, v51 row_newbcast:8 row_mask:0xf bank_mask:0xf
    s_nop 1
    v_mfma_f32_16x16x32_bf16 v[56:59], v[52:55], v[136:139], v[56:59]
    s_cbranch_vccnz L_m_101
    s_waitcnt vmcnt(4)
L_m_101:
    s_waitcnt vmcnt(6)
    buffer_load_dwordx4 v[136:139], v2, s[40:43], s55 offen offset:2048 nt
    v_and_b32_dpp v52, v20, v48 row_newbcast:12 row_mask:0xf bank_mask:0xf
    v_and_b32_dpp v53, v20, v49 row_newbcast:12 row_mask:0xf bank_mask:0xf
    v_and_b32_dpp v54, v20, v50 row_newbcast:12 row_mask:0xf bank_mask:0xf
    v_and_b32_dpp v55, v20, v51 row_newbcast:12 row_mask:0xf bank_mask:0xf
    s_nop 1
    v_mfma_f32_16x16x32_bf16 v[56:59], v[52:55], v[140:143], v[56:59]
    s_cbranch_vccnz L_m_103
    s_waitcnt vmcnt(4)
L_m_103:
    s_waitcnt vmcnt(6)
    buffer_load_dwordx4 v[140:143], v2, s[40:43], s55 offen offset:3072 nt
    v_and_b32_dpp v52, v20, v48 row_newbcast:1 row_mask:0xf bank_mask:0xf
    v_and_b32_dpp v53, v20, v49 row_newbcast:1 row_mask:0xf bank_mask:0xf
    v_and_b32_dpp v54, v20, v50 row_newbcast:1 row_mask:0xf bank_mask:0xf
    v_and_b32_dpp v55, v20, v51 row_newbcast:1 row_mask:0xf bank_mask:0xf
    s_nop 1
    v_mfma_f32_16x16x32_bf16 v[56:59], v[52:55], v[144:147], v[56:59]
    s_cbranch_vccnz L_m_105
    s_waitcnt vmcnt(4)
L_m_105:
    s_waitcnt vmcnt(6)
    buffer_load_dwordx4 v[144:147], v3, s[40:43], s55 offen offset:0 nt
    v_and_b32_dpp v52, v20, v48 row_newbcast:5 row_mask:0xf bank_mask:0xf
    v_and_b32_dpp v53, v20, v49 row_newbcast:5 row_mask:0xf bank_mask:0xf
    v_and_b32_dpp v54, v20, v50 row_newbcast:5 row_mask:0xf bank_mask:0xf
    v_and_b32_dpp v55, v20, v51 row_newbcast:5 row_mask:0xf bank_mask:0xf
    s_nop 1
    v_mfma_f32_16x16x32_bf16 v[56:59], v[52:55], v[148:151], v[56:59]
    s_cbranch_vccnz L_m_107
    s_waitcnt vmcnt(4)
L_m_107:
    s_waitcnt vmcnt(6)
    buffer_load_dwordx4 v[148:151], v3, s[40:43], s55 offen offset:1024 nt
    v_and_b32_dpp v52, v20, v48 row_newbcast:9 row_mask:0xf bank_mask:0xf
    v_and_b32_dpp v53, v20, v49 row_newbcast:9 row_mask:0xf bank_mask:0xf
    v_and_b32_dpp v54, v20, v50 row_newbcast:9 row_mask:0xf bank_mask:0xf
    v_and_b32_dpp v55, v20, v51 row_newbcast:9 row_mask:0xf bank_mask:0xf
    s_nop 1
    v_mfma_f32_16x16x32_bf16 v[56:59], v[52:55], v[152:155], v[56:59]
    s_cbranch_vccnz L_m_109
    s_waitcnt vmcnt(4)
L_m_109:
    s_waitcnt vmcnt(6)
    buffer_load_dwordx4 v[152:155], v3, s[40:43], s55 offen offset:2048 nt
    v_and_b32_dpp v52, v20, v48 row_newbcast:13 row_mask:0xf bank_mask:0xf
    v_and_b32_dpp v53, v20, v49 row_newbcast:13 row_mask:0xf bank_mask:0xf
    v_and_b32_dpp v54, v20, v50 row_newbcast:13 row_mask:0xf bank_mask:0xf
    v_and_b32_dpp v55, v20, v51 row_newbcast:13 row_mask:0xf bank_mask:0xf
    s_nop 1
    v_mfma_f32_16x16x32_bf16 v[56:59], v[52:55], v[156:159], v[56:59]
    s_cbranch_vccnz L_m_111
    s_waitcnt vmcnt(4)
L_m_111:
    s_waitcnt vmcnt(6)
    buffer_load_dwordx4 v[156:159], v3, s[40:43], s55 offen offset:3072 nt
    v_and_b32_dpp v52, v20, v48 row_newbcast:2 row_mask:0xf bank_mask:0xf
    v_and_b32_dpp v53, v20, v49 row_newbcast:2 row_mask:0xf bank_mask:0xf
    v_and_b32_dpp v54, v20, v50 row_newbcast:2 row_mask:0xf bank_mask:0xf
    v_and_b32_dpp v55, v20, v51 row_newbcast:2 row_mask:0xf bank_mask:0xf
    s_nop 1
    v_mfma_f32_16x16x32_bf16 v[56:59], v[52:55], v[160:163], v[56:59]
    s_cbranch_vccnz L_m_113
    s_waitcnt vmcnt(4)
L_m_113:
    s_waitcnt vmcnt(6)
    buffer_load_dwordx4 v[160:163], v4, s[40:43], s55 offen offset:0 nt
    v_and_b32_dpp v52, v20, v48 row_newbcast:6 row_mask:0xf bank_mask:0xf
    v_and_b32_dpp v53, v20, v49 row_newbcast:6 row_mask:0xf bank_mask:0xf
    v_and_b32_dpp v54, v20, v50 row_newbcast:6 row_mask:0xf bank_mask:0xf
    v_and_b32_dpp v55, v20, v51 row_newbcast:6 row_mask:0xf bank_mask:0xf
    s_nop 1
    v_mfma_f32_16x16x32_bf16 v[56:59], v[52:55], v[164:167], v[56:59]
    s_cbranch_vccnz L_m_115
    s_waitcnt vmcnt(4)
L_m_115:
    s_waitcnt vmcnt(6)
    buffer_load_dwordx4 v[164:167], v4, s[40:43], s55 offen offset:1024 nt
    v_and_b32_dpp v52, v20, v48 row_newbcast:10 row_mask:0xf bank_mask:0xf
    v_and_b32_dpp v53, v20, v49 row_newbcast:10 row_mask:0xf bank_mask:0xf
    v_and_b32_dpp v54, v20, v50 row_newbcast:10 row_mask:0xf bank_mask:0xf
    v_and_b32_dpp v55, v20, v51 row_newbcast:10 row_mask:0xf bank_mask:0xf
    s_nop 1
    v_mfma_f32_16x16x32_bf16 v[56:59], v[52:55], v[168:171], v[56:59]
    s_cbranch_vccnz L_m_117
    s_waitcnt vmcnt(4)
L_m_117:
    s_waitcnt vmcnt(6)
    buffer_load_dwordx4 v[168:171], v4, s[40:43], s55 offen offset:2048 nt
    v_and_b32_dpp v52, v20, v48 row_newbcast:14 row_mask:0xf bank_mask:0xf
    v_and_b32_dpp v53, v20, v49 row_newbcast:14 row_mask:0xf bank_mask:0xf
    v_and_b32_dpp v54, v20, v50 row_newbcast:14 row_mask:0xf bank_mask:0xf
    v_and_b32_dpp v55, v20, v51 row_newbcast:14 row_mask:0xf bank_mask:0xf
    s_nop 1
    v_mfma_f32_16x16x32_bf16 v[56:59], v[52:55], v[172:175], v[56:59]
    s_cbranch_vccnz L_m_119
    s_waitcnt vmcnt(4)
L_m_119:
    s_waitcnt vmcnt(6)
    buffer_load_dwordx4 v[172:175], v4, s[40:43], s55 offen offset:3072 nt
    v_and_b32_dpp v52, v20, v48 row_newbcast:3 row_mask:0xf bank_mask:0xf
    v_and_b32_dpp v53, v20, v49 row_newbcast:3 row_mask:0xf bank_mask:0xf
    v_and_b32_dpp v54, v20, v50 row_newbcast:3 row_mask:0xf bank_mask:0xf
    v_and_b32_dpp v55, v20, v51 row_newbcast:3 row_mask:0xf bank_mask:0xf
    s_nop 1
    v_mfma_f32_16x16x32_bf16 v[56:59], v[52:55], v[176:179], v[56:59]
    s_cbranch_vccnz L_m_121
    s_waitcnt vmcnt(4)
L_m_121:
    s_waitcnt vmcnt(6)
    buffer_load_dwordx4 v[176:179], v5, s[40:43], s55 offen offset:0 nt
    v_and_b32_dpp v52, v20, v48 row_newbcast:7 row_mask:0xf bank_mask:0xf
    v_and_b32_dpp v53, v20, v49 row_newbcast:7 row_mask:0xf bank_mask:0xf
    v_and_b32_dpp v54, v20, v50 row_newbcast:7 row_mask:0xf bank_mask:0xf
    v_and_b32_dpp v55, v20, v51 row_newbcast:7 row_mask:0xf bank_mask:0xf
    s_nop 1
    v_mfma_f32_16x16x32_bf16 v[56:59], v[52:55], v[180:183], v[56:59]
    s_cbranch_vccnz L_m_123
    s_waitcnt vmcnt(4)
L_m_123:
    s_waitcnt vmcnt(6)
    buffer_load_dwordx4 v[180:183], v5, s[40:43], s55 offen offset:1024 nt
    v_and_b32_dpp v52, v20, v48 row_newbcast:11 row_mask:0xf bank_mask:0xf
    v_and_b32_dpp v53, v20, v49 row_newbcast:11 row_mask:0xf bank_mask:0xf
    v_and_b32_dpp v54, v20, v50 row_newbcast:11 row_mask:0xf bank_mask:0xf
    v_and_b32_dpp v55, v20, v51 row_newbcast:11 row_mask:0xf bank_mask:0xf
    s_nop 1
    v_mfma_f32_16x16x32_bf16 v[56:59], v[52:55], v[184:187], v[56:59]
    s_cbranch_vccnz L_m_125
    s_waitcnt vmcnt(4)
L_m_125:
    s_waitcnt vmcnt(6)
    buffer_load_dwordx4 v[184:187], v5, s[40:43], s55 offen offset:2048 nt
    v_and_b32_dpp v52, v20, v48 row_newbcast:15 row_mask:0xf bank_mask:0xf
    v_and_b32_dpp v53, v20, v49 row_newbcast:15 row_mask:0xf bank_mask:0xf
    v_and_b32_dpp v54, v20, v50 row_newbcast:15 row_mask:0xf bank_mask:0xf
    v_and_b32_dpp v55, v20, v51 row_newbcast:15 row_mask:0xf bank_mask:0xf
    s_nop 1
    v_mfma_f32_16x16x32_bf16 v[56:59], v[52:55], v[188:191], v[56:59]
    ds_read_b32 v10, v21 offset:20
    s_cbranch_vccnz L_m_127
    s_waitcnt vmcnt(4)
L_m_127:
    s_waitcnt vmcnt(6)
    buffer_load_dwordx4 v[188:191], v5, s[40:43], s55 offen offset:3072 nt
    s_add_u32 s52, s52, 1
    s_cmp_lt_u32 s52, 28
    s_cbranch_scc1 L_vloop
    s_add_u32 s51, s51, 0x20000
    s_add_u32 s55, s55, 0x20000
    s_waitcnt lgkmcnt(0)
    v_fma_f32 v17, v19, s53, v18
    ds_read_b32 v216, v12 offset:256
    ds_read_b32 v217, v12 offset:512
    ds_read_b32 v218, v12 offset:768
    ds_read_b32 v61, v21 offset:24
    v_exp_f32 v17, v17
    v_mov_b32 v60, s52
    ds_write_b32 v11, v60 offset:32
    v_readfirstlane_b32 s54, v10
    s_nop 0
    s_cmp_lt_u32 s52, s54
    s_cselect_b64 vcc, -1, 0
    v_cvt_pk_bf16_f32 v20, v17, v17
    s_nop 1
    v_and_b32_dpp v52, v20, v48 row_newbcast:0 row_mask:0xf bank_mask:0xf
    v_and_b32_dpp v53, v20, v49 row_newbcast:0 row_mask:0xf bank_mask:0xf
    v_and_b32_dpp v54, v20, v50 row_newbcast:0 row_mask:0xf bank_mask:0xf
    v_and_b32_dpp v55, v20, v51 row_newbcast:0 row_mask:0xf bank_mask:0xf
    v_and_b32_dpp v212, v20, v48 row_newbcast:4 row_mask:0xf bank_mask:0xf
    v_and_b32_dpp v213, v20, v49 row_newbcast:4 row_mask:0xf bank_mask:0xf
    v_and_b32_dpp v214, v20, v50 row_newbcast:4 row_mask:0xf bank_mask:0xf
    v_and_b32_dpp v215, v20, v51 row_newbcast:4 row_mask:0xf bank_mask:0xf
    v_mfma_f32_16x16x32_bf16 v[56:59], v[52:55], v[64:67], v[56:59]
    s_cbranch_vccnz L_m_129
    s_waitcnt vmcnt(4)
L_m_129:
    s_waitcnt vmcnt(6)
    buffer_load_dwordx4 v[64:67], v2, s[40:43], s51 offen offset:0 nt
    s_waitcnt lgkmcnt(0)
    v_fma_f32 v216, v216, s53, v18
    v_fma_f32 v217, v217, s53, v18
    v_fma_f32 v218, v218, s53, v18
    v_exp_f32 v216, v216
    v_exp_f32 v217, v217
    v_exp_f32 v218, v218
    v_and_b32 v15, 15, v1
    v_lshlrev_b32 v15, 5, v15
    v_lshrrev_b32 v17, 4, v1
    v_lshl_add_u32 v15, v17, 4, v15
    s_lshl_b32 s54, s3, 9
    s_add_u32 s54, s54, 0x22100
    v_add_u32 v15, s54, v15
    v_cvt_pk_bf16_f32 v216, v216, v216
    v_cvt_pk_bf16_f32 v217, v217, v217
    v_cvt_pk_bf16_f32 v218, v218, v218
    s_mov_b32 s36, s26
    s_mov_b32 s37, s27
    s_mov_b32 s38, 0x600000
    s_mov_b32 s39, 0x20000
    v_and_b32_dpp v52, v20, v48 row_newbcast:8 row_mask:0xf bank_mask:0xf
    v_and_b32_dpp v53, v20, v49 row_newbcast:8 row_mask:0xf bank_mask:0xf
    v_and_b32_dpp v54, v20, v50 row_newbcast:8 row_mask:0xf bank_mask:0xf
    v_and_b32_dpp v55, v20, v51 row_newbcast:8 row_mask:0xf bank_mask:0xf
    v_mfma_f32_16x16x32_bf16 v[56:59], v[212:215], v[68:71], v[56:59]
    s_cbranch_vccnz L_m_131
    s_waitcnt vmcnt(4)
L_m_131:
    s_waitcnt vmcnt(6)
    buffer_load_dwordx4 v[68:71], v2, s[40:43], s51 offen offset:1024 nt
    s_waitcnt lgkmcnt(0)
    v_readfirstlane_b32 s57, v61
    s_nop 0
    ds_read_b32 v61, v21 offset:24
    s_cmp_ge_u32 s57, 10
    s_cbranch_scc1 L_fast2
    v_and_b32_dpp v212, v20, v48 row_newbcast:12 row_mask:0xf bank_mask:0xf
    v_and_b32_dpp v213, v20, v49 row_newbcast:12 row_mask:0xf bank_mask:0xf
    v_and_b32_dpp v214, v20, v50 row_newbcast:12 row_mask:0xf bank_mask:0xf
    v_and_b32_dpp v215, v20, v51 row_newbcast:12 row_mask:0xf bank_mask:0xf
    v_mfma_f32_16x16x32_bf16 v[56:59], v[52:55], v[72:75], v[56:59]
    s_cbranch_vccnz L_m_133
    s_waitcnt vmcnt(4)
L_m_133:
    s_waitcnt vmcnt(6)
    buffer_load_dwordx4 v[72:75], v2, s[40:43], s51 offen offset:2048 nt
    v_and_b32_dpp v52, v20, v48 row_newbcast:1 row_mask:0xf bank_mask:0xf
    v_and_b32_dpp v53, v20, v49 row_newbcast:1 row_mask:0xf bank_mask:0xf
    v_and_b32_dpp v54, v20, v50 row_newbcast:1 row_mask:0xf bank_mask:0xf
    v_and_b32_dpp v55, v20, v51 row_newbcast:1 row_mask:0xf bank_mask:0xf
    v_mfma_f32_16x16x32_bf16 v[56:59], v[212:215], v[76:79], v[56:59]
    s_cbranch_vccnz L_m_135
    s_waitcnt vmcnt(4)
L_m_135:
    s_waitcnt vmcnt(6)
    buffer_load_dwordx4 v[76:79], v2, s[40:43], s51 offen offset:3072 nt
    s_waitcnt lgkmcnt(0)
    v_readfirstlane_b32 s57, v61
    s_nop 0
    ds_read_b32 v61, v21 offset:24
    s_cmp_ge_u32 s57, 9
    s_cbranch_scc1 L_fast4
    v_and_b32_dpp v212, v20, v48 row_newbcast:5 row_mask:0xf bank_mask:0xf
    v_and_b32_dpp v213, v20, v49 row_newbcast:5 row_mask:0xf bank_mask:0xf
    v_and_b32_dpp v214, v20, v50 row_newbcast:5 row_mask:0xf bank_mask:0xf
    v_and_b32_dpp v215, v20, v51 row_newbcast:5 row_mask:0xf bank_mask:0xf
    v_mfma_f32_16x16x32_bf16 v[56:59], v[52:55], v[80:83], v[56:59]
    s_cbranch_vccnz L_m_137
    s_waitcnt vmcnt(4)
L_m_137:
    s_waitcnt vmcnt(6)
    buffer_load_dwordx4 v[80:83], v3, s[40:43], s51 offen offset:0 nt
    v_and_b32_dpp v52, v20, v48 row_newbcast:9 row_mask:0xf bank_mask:0xf
    v_and_b32_dpp v53, v20, v49 row_newbcast:9 row_mask:0xf bank_mask:0xf
    v_and_b32_dpp v54, v20, v50 row_newbcast:9 row_mask:0xf bank_mask:0xf
    v_and_b32_dpp v55, v20, v51 row_newbcast:9 row_mask:0xf bank_mask:0xf
    v_mfma_f32_16x16x32_bf16 v[56:59], v[212:215], v[84:87], v[56:59]
    s_cbranch_vccnz L_m_139
    s_waitcnt vmcnt(4)
L_m_139:
    s_waitcnt vmcnt(6)
    buffer_load_dwordx4 v[84:87], v3, s[40:43], s51 offen offset:1024 nt
    s_waitcnt lgkmcnt(0)
    v_readfirstlane_b32 s57, v61
    s_nop 0
    ds_read_b32 v61, v21 offset:24
    s_cmp_ge_u32 s57, 8
    s_cbranch_scc1 L_fast6
    v_and_b32_dpp v212, v20, v48 row_newbcast:13 row_mask:0xf bank_mask:0xf
    v_and_b32_dpp v213, v20, v49 row_newbcast:13 row_mask:0xf bank_mask:0xf
    v_and_b32_dpp v214, v20, v50 row_newbcast:13 row_mask:0xf bank_mask:0xf
    v_and_b32_dpp v215, v20, v51 row_newbcast:13 row_mask:0xf bank_mask:0xf
    v_mfma_f32_16x16x32_bf16 v[56:59], v[52:55], v[88:91], v[56:59]
    s_cbranch_vccnz L_m_141
    s_waitcnt vmcnt(4)
L_m_141:
    s_waitcnt vmcnt(6)
    buffer_load_dwordx4 v[88:91], v3, s[40:43], s51 offen offset:2048 nt
    v_and_b32_dpp v52, v20, v48 row_newbcast:2 row_mask:0xf bank_mask:0xf
    v_and_b32_dpp v53, v20, v49 row_newbcast:2 row_mask:0xf bank_mask:0xf
    v_and_b32_dpp v54, v20, v50 row_newbcast:2 row_mask:0xf bank_mask:0xf
    v_and_b32_dpp v55, v20, v51 row_newbcast:2 row_mask:0xf bank_mask:0xf
    v_mfma_f32_16x16x32_bf16 v[56:59], v[212:215], v[92:95], v[56:59]
    s_cbranch_vccnz L_m_143
    s_waitcnt vmcnt(4)
L_m_143:
    s_waitcnt vmcnt(6)
    buffer_load_dwordx4 v[92:95], v3, s[40:43], s51 offen offset:3072 nt
    s_waitcnt lgkmcnt(0)
    v_readfirstlane_b32 s57, v61
    s_nop 0
    ds_read_b32 v61, v21 offset:24
    s_cmp_ge_u32 s57, 7
    s_cbranch_scc1 L_fast8
    v_and_b32_dpp v212, v20, v48 row_newbcast:6 row_mask:0xf bank_mask:0xf
    v_and_b32_dpp v213, v20, v49 row_newbcast:6 row_mask:0xf bank_mask:0xf
    v_and_b32_dpp v214, v20, v50 row_newbcast:6 row_mask:0xf bank_mask:0xf
    v_and_b32_dpp v215, v20, v51 row_newbcast:6 row_mask:0xf bank_mask:0xf
    v_mfma_f32_16x16x32_bf16 v[56:59], v[52:55], v[96:99], v[56:59]
    s_cbranch_vccnz L_m_145
    s_waitcnt vmcnt(4)
L_m_145:
    s_waitcnt vmcnt(6)
    buffer_load_dwordx4 v[96:99], v4, s[40:43], s51 offen offset:0 nt
    v_and_b32_dpp v52, v20, v48 row_newbcast:10 row_mask:0xf bank_mask:0xf
    v_and_b32_dpp v53, v20, v49 row_newbcast:10 row_mask:0xf bank_mask:0xf
    v_and_b32_dpp v54, v20, v50 row_newbcast:10 row_mask:0xf bank_mask:0xf
    v_and_b32_dpp v55, v20, v51 row_newbcast:10 row_mask:0xf bank_mask:0xf
    v_mfma_f32_16x16x32_bf16 v[56:59], v[212:215], v[100:103], v[56:59]
    s_cbranch_vccnz L_m_147
    s_waitcnt vmcnt(4)
L_m_147:
    s_waitcnt vmcnt(6)
    buffer_load_dwordx4 v[100:103], v4, s[40:43], s51 offen offset:1024 nt
    s_waitcnt lgkmcnt(0)
    v_readfirstlane_b32 s57, v61
    s_nop 0
    ds_read_b32 v61, v21 offset:24
    s_cmp_ge_u32 s57, 6
    s_cbranch_scc1 L_fast10
    v_and_b32_dpp v212, v20, v48 row_newbcast:14 row_mask:0xf bank_mask:0xf
    v_and_b32_dpp v213, v20, v49 row_newbcast:14 row_mask:0xf bank_mask:0xf
    v_and_b32_dpp v214, v20, v50 row_newbcast:14 row_mask:0xf bank_mask:0xf
    v_and_b32_dpp v215, v20, v51 row_newbcast:14 row_mask:0xf bank_mask:0xf
    v_mfma_f32_16x16x32_bf16 v[56:59], v[52:55], v[104:107], v[56:59]
    s_cbranch_vccnz L_m_149
    s_waitcnt vmcnt(4)
L_m_149:
    s_waitcnt vmcnt(6)
    buffer_load_dwordx4 v[104:107], v4, s[40:43], s51 offen offset:2048 nt
    v_and_b32_dpp v52, v20, v48 row_newbcast:3 row_mask:0xf bank_mask:0xf
    v_and_b32_dpp v53, v20, v49 row_newbcast:3 row_mask:0xf bank_mask:0xf
    v_and_b32_dpp v54, v20, v50 row_newbcast:3 row_mask:0xf bank_mask:0xf
    v_and_b32_dpp v55, v20, v51 row_newbcast:3 row_mask:0xf bank_mask:0xf
    v_mfma_f32_16x16x32_bf16 v[56:59], v[212:215], v[108:111], v[56:59]
    s_cbranch_vccnz L_m_151
    s_waitcnt vmcnt(4)
L_m_151:
    s_waitcnt vmcnt(6)
    buffer_load_dwordx4 v[108:111], v4, s[40:43], s51 offen offset:3072 nt
    s_waitcnt lgkmcnt(0)
    v_readfirstlane_b32 s57, v61
    s_nop 0
    ds_read_b32 v61, v21 offset:24
    s_cmp_ge_u32 s57, 5
    s_cbranch_scc1 L_fast12
    v_and_b32_dpp v212, v20, v48 row_newbcast:7 row_mask:0xf bank_mask:0xf
    v_and_b32_dpp v213, v20, v49 row_newbcast:7 row_mask:0xf bank_mask:0xf
    v_and_b32_dpp v214, v20, v50 row_newbcast:7 row_mask:0xf bank_mask:0xf
    v_and_b32_dpp v215, v20, v51 row_newbcast:7 row_mask:0xf bank_mask:0xf
    v_mfma_f32_16x16x32_bf16 v[56:59], v[52:55], v[112:115], v[56:59]
    s_cbranch_vccnz L_m_153
    s_waitcnt vmcnt(4)
L_m_153:
    s_waitcnt vmcnt(6)
    buffer_load_dwordx4 v[112:115], v5, s[40:43], s51 offen offset:0 nt
    v_and_b32_dpp v52, v20, v48 row_newbcast:11 row_mask:0xf bank_mask:0xf
    v_and_b32_dpp v53, v20, v49 row_newbcast:11 row_mask:0xf bank_mask:0xf
    v_and_b32_dpp v54, v20, v50 row_newbcast:11 row_mask:0xf bank_mask:0xf
    v_and_b32_dpp v55, v20, v51 row_newbcast:11 row_mask:0xf bank_mask:0xf
    v_mfma_f32_16x16x32_bf16 v[56:59], v[212:215], v[116:119], v[56:59]
    s_cbranch_vccnz L_m_155
    s_waitcnt vmcnt(4)
L_m_155:
    s_waitcnt vmcnt(6)
    buffer_load_dwordx4 v[116:119], v5, s[40:43], s51 offen offset:1024 nt
    s_waitcnt lgkmcnt(0)
    v_readfirstlane_b32 s57, v61
    s_nop 0
    ds_read_b32 v61, v21 offset:24
    s_cmp_ge_u32 s57, 4
    s_cbranch_scc1 L_fast14
    v_and_b32_dpp v212, v20, v48 row_newbcast:15 row_mask:0xf bank_mask:0xf
    v_and_b32_dpp v213, v20, v49 row_newbcast:15 row_mask:0xf bank_mask:0xf
    v_and_b32_dpp v214, v20, v50 row_newbcast:15 row_mask:0xf bank_mask:0xf
    v_and_b32_dpp v215, v20, v51 row_newbcast:15 row_mask:0xf bank_mask:0xf
    v_mfma_f32_16x16x32_bf16 v[56:59], v[52:55], v[120:123], v[56:59]
    s_cbranch_vccnz L_m_157
    s_waitcnt vmcnt(4)
L_m_157:
    s_waitcnt vmcnt(6)
    buffer_load_dwordx4 v[120:123], v5, s[40:43], s51 offen offset:2048 nt
    v_and_b32_dpp v52, v216, v48 row_newbcast:0 row_mask:0xf bank_mask:0xf
    v_and_b32_dpp v53, v216, v49 row_newbcast:0 row_mask:0xf bank_mask:0xf
    v_and_b32_dpp v54, v216, v50 row_newbcast:0 row_mask:0xf bank_mask:0xf
    v_and_b32_dpp v55, v216, v51 row_newbcast:0 row_mask:0xf bank_mask:0xf
    v_mfma_f32_16x16x32_bf16 v[56:59], v[212:215], v[124:127], v[56:59]
    s_cbranch_vccnz L_m_159
    s_waitcnt vmcnt(4)
L_m_159:
    s_waitcnt vmcnt(6)
    buffer_load_dwordx4 v[124:127], v5, s[40:43], s51 offen offset:3072 nt
    s_waitcnt lgkmcnt(0)
    v_readfirstlane_b32 s57, v61
    s_nop 0
    ds_read_b32 v61, v21 offset:24
    s_cmp_ge_u32 s57, 3
    s_cbranch_scc1 L_fast16
    v_and_b32_dpp v212, v216, v48 row_newbcast:4 row_mask:0xf bank_mask:0xf
    v_and_b32_dpp v213, v216, v49 row_newbcast:4 row_mask:0xf bank_mask:0xf
    v_and_b32_dpp v214, v216, v50 row_newbcast:4 row_mask:0xf bank_mask:0xf
    v_and_b32_dpp v215, v216, v51 row_newbcast:4 row_mask:0xf bank_mask:0xf
    v_mfma_f32_16x16x32_bf16 v[56:59], v[52:55], v[128:131], v[56:59]
    s_cbranch_vccnz L_m_161
    s_waitcnt vmcnt(4)
L_m_161:
    s_waitcnt vmcnt(6)
    buffer_load_dwordx4 v[128:131], v2, s[40:43], s55 offen offset:0 nt
    v_and_b32_dpp v52, v216, v48 row_newbcast:8 row_mask:0xf bank_mask:0xf
    v_and_b32_dpp v53, v216, v49 row_newbcast:8 row_mask:0xf bank_mask:0xf
    v_and_b32_dpp v54, v216, v50 row_newbcast:8 row_mask:0xf bank_mask:0xf
    v_and_b32_dpp v55, v216, v51 row_newbcast:8 row_mask:0xf bank_mask:0xf
    v_mfma_f32_16x16x32_bf16 v[56:59], v[212:215], v[132:135], v[56:59]
    s_cbranch_vccnz L_m_163
    s_waitcnt vmcnt(4)
L_m_163:
    s_waitcnt vmcnt(6)
    buffer_load_dwordx4 v[132:135], v2, s[40:43], s55 offen offset:1024 nt
    s_waitcnt lgkmcnt(0)
    v_readfirstlane_b32 s57, v61
    s_nop 0
    ds_read_b32 v61, v21 offset:24
    s_cmp_ge_u32 s57, 2
    s_cbranch_scc1 L_fast18
    v_and_b32_dpp v212, v216, v48 row_newbcast:12 row_mask:0xf bank_mask:0xf
    v_and_b32_dpp v213, v216, v49 row_newbcast:12 row_mask:0xf bank_mask:0xf
    v_and_b32_dpp v214, v216, v50 row_newbcast:12 row_mask:0xf bank_mask:0xf
    v_and_b32_dpp v215, v216, v51 row_newbcast:12 row_mask:0xf bank_mask:0xf
    v_mfma_f32_16x16x32_bf16 v[56:59], v[52:55], v[136:139], v[56:59]
    s_cbranch_vccnz L_m_165
    s_waitcnt vmcnt(4)
L_m_165:
    s_waitcnt vmcnt(6)
    buffer_load_dwordx4 v[136:139], v2, s[40:43], s55 offen offset:2048 nt
    v_and_b32_dpp v52, v216, v48 row_newbcast:1 row_mask:0xf bank_mask:0xf
    v_and_b32_dpp v53, v216, v49 row_newbcast:1 row_mask:0xf bank_mask:0xf
    v_and_b32_dpp v54, v216, v50 row_newbcast:1 row_mask:0xf bank_mask:0xf
    v_and_b32_dpp v55, v216, v51 row_newbcast:1 row_mask:0xf bank_mask:0xf
    v_mfma_f32_16x16x32_bf16 v[56:59], v[212:215], v[140:143], v[56:59]
    s_cbranch_vccnz L_m_167
    s_waitcnt vmcnt(4)
L_m_167:
    s_waitcnt vmcnt(6)
    buffer_load_dwordx4 v[140:143], v2, s[40:43], s55 offen offset:3072 nt
    s_waitcnt lgkmcnt(0)
    v_readfirstlane_b32 s57, v61
    s_nop 0
    ds_read_b32 v61, v21 offset:24
    s_cmp_ge_u32 s57, 1
    s_cbranch_scc1 L_fast20
    v_and_b32_dpp v212, v216, v48 row_newbcast:5 row_mask:0xf bank_mask:0xf
    v_and_b32_dpp v213, v216, v49 row_newbcast:5 row_mask:0xf bank_mask:0xf
    v_and_b32_dpp v214, v216, v50 row_newbcast:5 row_mask:0xf bank_mask:0xf
    v_and_b32_dpp v215, v216, v51 row_newbcast:5 row_mask:0xf bank_mask:0xf
    v_mfma_f32_16x16x32_bf16 v[56:59], v[52:55], v[144:147], v[56:59]
    s_cbranch_vccnz L_m_169
    s_waitcnt vmcnt(4)
L_m_169:
    s_waitcnt vmcnt(6)
    buffer_load_dwordx4 v[144:147], v3, s[40:43], s55 offen offset:0 nt
    v_and_b32_dpp v52, v216, v48 row_newbcast:9 row_mask:0xf bank_mask:0xf
    v_and_b32_dpp v53, v216, v49 row_newbcast:9 row_mask:0xf bank_mask:0xf
    v_and_b32_dpp v54, v216, v50 row_newbcast:9 row_mask:0xf bank_mask:0xf
    v_and_b32_dpp v55, v216, v51 row_newbcast:9 row_mask:0xf bank_mask:0xf
    v_mfma_f32_16x16x32_bf16 v[56:59], v[212:215], v[148:151], v[56:59]
    s_cbranch_vccnz L_m_171
    s_waitcnt vmcnt(4)
L_m_171:
    s_waitcnt vmcnt(6)
    buffer_load_dwordx4 v[148:151], v3, s[40:43], s55 offen offset:1024 nt
    s_branch L_fast22
L_fast2:
    ds_write_b32 v21, v62 offset:24
    v_and_b32_dpp v212, v20, v48 row_newbcast:12 row_mask:0xf bank_mask:0xf
    v_and_b32_dpp v213, v20, v49 row_newbcast:12 row_mask:0xf bank_mask:0xf
    v_and_b32_dpp v214, v20, v50 row_newbcast:12 row_mask:0xf bank_mask:0xf
    v_and_b32_dpp v215, v20, v51 row_newbcast:12 row_mask:0xf bank_mask:0xf
    s_waitcnt vmcnt(31)
    v_mfma_f32_16x16x32_bf16 v[56:59], v[52:55], v[72:75], v[56:59]
    buffer_load_dwordx4 v[72:75], v2, s[40:43], s51 offen offset:2048 nt
    v_and_b32_dpp v52, v20, v48 row_newbcast:1 row_mask:0xf bank_mask:0xf
    v_and_b32_dpp v53, v20, v49 row_newbcast:1 row_mask:0xf bank_mask:0xf
    v_and_b32_dpp v54, v20, v50 row_newbcast:1 row_mask:0xf bank_mask:0xf
    v_and_b32_dpp v55, v20, v51 row_newbcast:1 row_mask:0xf bank_mask:0xf
    s_waitcnt vmcnt(31)
    v_mfma_f32_16x16x32_bf16 v[56:59], v[212:215], v[76:79], v[56:59]
    buffer_load_dwordx4 v[76:79], v2, s[40:43], s51 offen offset:3072 nt
L_fast4:
    v_and_b32_dpp v212, v20, v48 row_newbcast:5 row_mask:0xf bank_mask:0xf
    v_and_b32_dpp v213, v20, v49 row_newbcast:5 row_mask:0xf bank_mask:0xf
    v_and_b32_dpp v214, v20, v50 row_newbcast:5 row_mask:0xf bank_mask:0xf
    v_and_b32_dpp v215, v20, v51 row_newbcast:5 row_mask:0xf bank_mask:0xf
    s_waitcnt vmcnt(31)
    v_mfma_f32_16x16x32_bf16 v[56:59], v[52:55], v[80:83], v[56:59]
    buffer_load_dwordx4 v[80:83], v3, s[40:43], s51 offen offset:0 nt
    v_and_b32_dpp v52, v20, v48 row_newbcast:9 row_mask:0xf bank_mask:0xf
    v_and_b32_dpp v53, v20, v49 row_newbcast:9 row_mask:0xf bank_mask:0xf
    v_and_b32_dpp v54, v20, v50 row_newbcast:9 row_mask:0xf bank_mask:0xf
    v_and_b32_dpp v55, v20, v51 row_newbcast:9 row_mask:0xf bank_mask:0xf
    s_waitcnt vmcnt(31)
    v_mfma_f32_16x16x32_bf16 v[56:59], v[212:215], v[84:87], v[56:59]
    buffer_load_dwordx4 v[84:87], v3, s[40:43], s51 offen offset:1024 nt
L_fast6:
    ds_write_b32 v21, v62 offset:24
    v_and_b32_dpp v212, v20, v48 row_newbcast:13 row_mask:0xf bank_mask:0xf
    v_and_b32_dpp v213, v20, v49 row_newbcast:13 row_mask:0xf bank_mask:0xf
    v_and_b32_dpp v214, v20, v50 row_newbcast:13 row_mask:0xf bank_mask:0xf
    v_and_b32_dpp v215, v20, v51 row_newbcast:13 row_mask:0xf bank_mask:0xf
    s_waitcnt vmcnt(31)
    v_mfma_f32_16x16x32_bf16 v[56:59], v[52:55], v[88:91], v[56:59]
    buffer_load_dwordx4 v[88:91], v3, s[40:43], s51 offen offset:2048 nt
    v_and_b32_dpp v52, v20, v48 row_newbcast:2 row_mask:0xf bank_mask:0xf
    v_and_b32_dpp v53, v20, v49 row_newbcast:2 row_mask:0xf bank_mask:0xf
    v_and_b32_dpp v54, v20, v50 row_newbcast:2 row_mask:0xf bank_mask:0xf
    v_and_b32_dpp v55, v20, v51 row_newbcast:2 row_mask:0xf bank_mask:0xf
    s_waitcnt vmcnt(31)
    v_mfma_f32_16x16x32_bf16 v[56:59], v[212:215], v[92:95], v[56:59]
    buffer_load_dwordx4 v[92:95], v3, s[40:43], s51 offen offset:3072 nt
L_fast8:
    v_and_b32_dpp v212, v20, v48 row_newbcast:6 row_mask:0xf bank_mask:0xf
    v_and_b32_dpp v213, v20, v49 row_newbcast:6 row_mask:0xf bank_mask:0xf
    v_and_b32_dpp v214, v20, v50 row_newbcast:6 row_mask:0xf bank_mask:0xf
    v_and_b32_dpp v215, v20, v51 row_newbcast:6 row_mask:0xf bank_mask:0xf
    s_waitcnt vmcnt(31)
    v_mfma_f32_16x16x32_bf16 v[56:59], v[52:55], v[96:99], v[56:59]
    buffer_load_dwordx4 v[96:99], v4, s[40:43], s51 offen offset:0 nt
    v_and_b32_dpp v52, v20, v48 row_newbcast:10 row_mask:0xf bank_mask:0xf
    v_and_b32_dpp v53, v20, v49 row_newbcast:10 row_mask:0xf bank_mask:0xf
    v_and_b32_dpp v54, v20, v50 row_newbcast:10 row_mask:0xf bank_mask:0xf
    v_and_b32_dpp v55, v20, v51 row_newbcast:10 row_mask:0xf bank_mask:0xf
    s_waitcnt vmcnt(31)
    v_mfma_f32_16x16x32_bf16 v[56:59], v[212:215], v[100:103], v[56:59]
    buffer_load_dwordx4 v[100:103], v4, s[40:43], s51 offen offset:1024 nt
L_fast10:
    ds_write_b32 v21, v62 offset:24
    v_and_b32_dpp v212, v20, v48 row_newbcast:14 row_mask:0xf bank_mask:0xf
    v_and_b32_dpp v213, v20, v49 row_newbcast:14 row_mask:0xf bank_mask:0xf
    v_and_b32_dpp v214, v20, v50 row_newbcast:14 row_mask:0xf bank_mask:0xf
    v_and_b32_dpp v215, v20, v51 row_newbcast:14 row_mask:0xf bank_mask:0xf
    s_waitcnt vmcnt(31)
    v_mfma_f32_16x16x32_bf16 v[56:59], v[52:55], v[104:107], v[56:59]
    buffer_load_dwordx4 v[104:107], v4, s[40:43], s51 offen offset:2048 nt
    v_and_b32_dpp v52, v20, v48 row_newbcast:3 row_mask:0xf bank_mask:0xf
    v_and_b32_dpp v53, v20, v49 row_newbcast:3 row_mask:0xf bank_mask:0xf
    v_and_b32_dpp v54, v20, v50 row_newbcast:3 row_mask:0xf bank_mask:0xf
    v_and_b32_dpp v55, v20, v51 row_newbcast:3 row_mask:0xf bank_mask:0xf
    s_waitcnt vmcnt(31)
    v_mfma_f32_16x16x32_bf16 v[56:59], v[212:215], v[108:111], v[56:59]
    buffer_load_dwordx4 v[108:111], v4, s[40:43], s51 offen offset:3072 nt
L_fast12:
    v_and_b32_dpp v212, v20, v48 row_newbcast:7 row_mask:0xf bank_mask:0xf
    v_and_b32_dpp v213, v20, v49 row_newbcast:7 row_mask:0xf bank_mask:0xf
    v_and_b32_dpp v214, v20, v50 row_newbcast:7 row_mask:0xf bank_mask:0xf
    v_and_b32_dpp v215, v20, v51 row_newbcast:7 row_mask:0xf bank_mask:0xf
    s_waitcnt vmcnt(31)
    v_mfma_f32_16x16x32_bf16 v[56:59], v[52:55], v[112:115], v[56:59]
    buffer_load_dwordx4 v[112:115], v5, s[40:43], s51 offen offset:0 nt
    v_and_b32_dpp v52, v20, v48 row_newbcast:11 row_mask:0xf bank_mask:0xf
    v_and_b32_dpp v53, v20, v49 row_newbcast:11 row_mask:0xf bank_mask:0xf
    v_and_b32_dpp v54, v20, v50 row_newbcast:11 row_mask:0xf bank_mask:0xf
    v_and_b32_dpp v55, v20, v51 row_newbcast:11 row_mask:0xf bank_mask:0xf
    s_waitcnt vmcnt(31)
    v_mfma_f32_16x16x32_bf16 v[56:59], v[212:215], v[116:119], v[56:59]
    buffer_load_dwordx4 v[116:119], v5, s[40:43], s51 offen offset:1024 nt
L_fast14:
    ds_write_b32 v21, v62 offset:24
    v_and_b32_dpp v212, v20, v48 row_newbcast:15 row_mask:0xf bank_mask:0xf
    v_and_b32_dpp v213, v20, v49 row_newbcast:15 row_mask:0xf bank_mask:0xf
    v_and_b32_dpp v214, v20, v50 row_newbcast:15 row_mask:0xf bank_mask:0xf
    v_and_b32_dpp v215, v20, v51 row_newbcast:15 row_mask:0xf bank_mask:0xf
    s_waitcnt vmcnt(31)
    v_mfma_f32_16x16x32_bf16 v[56:59], v[52:55], v[120:123], v[56:59]
    buffer_load_dwordx4 v[120:123], v5, s[40:43], s51 offen offset:2048 nt
    v_and_b32_dpp v52, v216, v48 row_newbcast:0 row_mask:0xf bank_mask:0xf
    v_and_b32_dpp v53, v216, v49 row_newbcast:0 row_mask:0xf bank_mask:0xf
    v_and_b32_dpp v54, v216, v50 row_newbcast:0 row_mask:0xf bank_mask:0xf
    v_and_b32_dpp v55, v216, v51 row_newbcast:0 row_mask:0xf bank_mask:0xf
    s_waitcnt vmcnt(31)
    v_mfma_f32_16x16x32_bf16 v[56:59], v[212:215], v[124:127], v[56:59]
    buffer_load_dwordx4 v[124:127], v5, s[40:43], s51 offen offset:3072 nt
L_fast16:
    v_and_b32_dpp v212, v216, v48 row_newbcast:4 row_mask:0xf bank_mask:0xf
    v_and_b32_dpp v213, v216, v49 row_newbcast:4 row_mask:0xf bank_mask:0xf
    v_and_b32_dpp v214, v216, v50 row_newbcast:4 row_mask:0xf bank_mask:0xf
    v_and_b32_dpp v215, v216, v51 row_newbcast:4 row_mask:0xf bank_mask:0xf
    s_waitcnt vmcnt(31)
    v_mfma_f32_16x16x32_bf16 v[56:59], v[52:55], v[128:131], v[56:59]
    buffer_load_dwordx4 v[128:131], v2, s[40:43], s55 offen offset:0 nt
    v_and_b32_dpp v52, v216, v48 row_newbcast:8 row_mask:0xf bank_mask:0xf
    v_and_b32_dpp v53, v216, v49 row_newbcast:8 row_mask:0xf bank_mask:0xf
    v_and_b32_dpp v54, v216, v50 row_newbcast:8 row_mask:0xf bank_mask:0xf
    v_and_b32_dpp v55, v216, v51 row_newbcast:8 row_mask:0xf bank_mask:0xf
    s_waitcnt vmcnt(31)
    v_mfma_f32_16x16x32_bf16 v[56:59], v[212:215], v[132:135], v[56:59]
    buffer_load_dwordx4 v[132:135], v2, s[40:43], s55 offen offset:1024 nt
L_fast18:
    ds_write_b32 v21, v62 offset:24
    v_and_b32_dpp v212, v216, v48 row_newbcast:12 row_mask:0xf bank_mask:0xf
    v_and_b32_dpp v213, v216, v49 row_newbcast:12 row_mask:0xf bank_mask:0xf
    v_and_b32_dpp v214, v216, v50 row_newbcast:12 row_mask:0xf bank_mask:0xf
    v_and_b32_dpp v215, v216, v51 row_newbcast:12 row_mask:0xf bank_mask:0xf
    s_waitcnt vmcnt(31)
    v_mfma_f32_16x16x32_bf16 v[56:59], v[52:55], v[136:139], v[56:59]
    buffer_load_dwordx4 v[136:139], v2, s[40:43], s55 offen offset:2048 nt
    v_and_b32_dpp v52, v216, v48 row_newbcast:1 row_mask:0xf bank_mask:0xf
    v_and_b32_dpp v53, v216, v49 row_newbcast:1 row_mask:0xf bank_mask:0xf
    v_and_b32_dpp v54, v216, v50 row_newbcast:1 row_mask:0xf bank_mask:0xf
    v_and_b32_dpp v55, v216, v51 row_newbcast:1 row_mask:0xf bank_mask:0xf
    s_waitcnt vmcnt(31)
    v_mfma_f32_16x16x32_bf16 v[56:59], v[212:215], v[140:143], v[56:59]
    buffer_load_dwordx4 v[140:143], v2, s[40:43], s55 offen offset:3072 nt
L_fast20:
    v_and_b32_dpp v212, v216, v48 row_newbcast:5 row_mask:0xf bank_mask:0xf
    v_and_b32_dpp v213, v216, v49 row_newbcast:5 row_mask:0xf bank_mask:0xf
    v_and_b32_dpp v214, v216, v50 row_newbcast:5 row_mask:0xf bank_mask:0xf
    v_and_b32_dpp v215, v216, v51 row_newbcast:5 row_mask:0xf bank_mask:0xf
    s_waitcnt vmcnt(31)
    v_mfma_f32_16x16x32_bf16 v[56:59], v[52:55], v[144:147], v[56:59]
    buffer_load_dwordx4 v[144:147], v3, s[40:43], s55 offen offset:0 nt
    v_and_b32_dpp v52, v216, v48 row_newbcast:9 row_mask:0xf bank_mask:0xf
    v_and_b32_dpp v53, v216, v49 row_newbcast:9 row_mask:0xf bank_mask:0xf
    v_and_b32_dpp v54, v216, v50 row_newbcast:9 row_mask:0xf bank_mask:0xf
    v_and_b32_dpp v55, v216, v51 row_newbcast:9 row_mask:0xf bank_mask:0xf
    s_waitcnt vmcnt(31)
    v_mfma_f32_16x16x32_bf16 v[56:59], v[212:215], v[148:151], v[56:59]
    buffer_load_dwordx4 v[148:151], v3, s[40:43], s55 offen offset:1024 nt
L_fast22:
    ds_write_b32 v21, v62 offset:24
    s_mov_b64 exec, 1
    ds_add_u32 v21, v62 offset:4
    s_mov_b64 exec, -1
    v_and_b32_dpp v212, v216, v48 row_newbcast:13 row_mask:0xf bank_mask:0xf
    v_and_b32_dpp v213, v216, v49 row_newbcast:13 row_mask:0xf bank_mask:0xf
    v_and_b32_dpp v214, v216, v50 row_newbcast:13 row_mask:0xf bank_mask:0xf
    v_and_b32_dpp v215, v216, v51 row_newbcast:13 row_mask:0xf bank_mask:0xf
    s_waitcnt vmcnt(31)
    v_mfma_f32_16x16x32_bf16 v[56:59], v[52:55], v[152:155], v[56:59]
    buffer_load_dwordx4 v[152:155], v3, s[40:43], s55 offen offset:2048 nt
    v_and_b32_dpp v52, v216, v48 row_newbcast:2 row_mask:0xf bank_mask:0xf
    v_and_b32_dpp v53, v216, v49 row_newbcast:2 row_mask:0xf bank_mask:0xf
    v_and_b32_dpp v54, v216, v50 row_newbcast:2 row_mask:0xf bank_mask:0xf
    v_and_b32_dpp v55, v216, v51 row_newbcast:2 row_mask:0xf bank_mask:0xf
    s_waitcnt vmcnt(31)
    v_mfma_f32_16x16x32_bf16 v[56:59], v[212:215], v[156:159], v[56:59]
    buffer_load_dwordx4 v[156:159], v3, s[40:43], s55 offen offset:3072 nt
    v_and_b32_dpp v212, v216, v48 row_newbcast:6 row_mask:0xf bank_mask:0xf
    v_and_b32_dpp v213, v216, v49 row_newbcast:6 row_mask:0xf bank_mask:0xf
    v_and_b32_dpp v214, v216, v50 row_newbcast:6 row_mask:0xf bank_mask:0xf
    v_and_b32_dpp v215, v216, v51 row_newbcast:6 row_mask:0xf bank_mask:0xf
    s_waitcnt vmcnt(31)
    v_mfma_f32_16x16x32_bf16 v[56:59], v[52:55], v[160:163], v[56:59]
    buffer_load_dwordx4 v[160:163], v4, s[40:43], s55 offen offset:0 nt
    v_and_b32_dpp v52, v216, v48 row_newbcast:10 row_mask:0xf bank_mask:0xf
    v_and_b32_dpp v53, v216, v49 row_newbcast:10 row_mask:0xf bank_mask:0xf
    v_and_b32_dpp v54, v216, v50 row_newbcast:10 row_mask:0xf bank_mask:0xf
    v_and_b32_dpp v55, v216, v51 row_newbcast:10 row_mask:0xf bank_mask:0xf
    s_waitcnt vmcnt(31)
    v_mfma_f32_16x16x32_bf16 v[56:59], v[212:215], v[164:167], v[56:59]
    buffer_load_dwordx4 v[164:167], v4, s[40:43], s55 offen offset:1024 nt
    v_and_b32_dpp v212, v216, v48 row_newbcast:14 row_mask:0xf bank_mask:0xf
    v_and_b32_dpp v213, v216, v49 row_newbcast:14 row_mask:0xf bank_mask:0xf
    v_and_b32_dpp v214, v216, v50 row_newbcast:14 row_mask:0xf bank_mask:0xf
    v_and_b32_dpp v215, v216, v51 row_newbcast:14 row_mask:0xf bank_mask:0xf
    s_waitcnt vmcnt(31)
    v_mfma_f32_16x16x32_bf16 v[56:59], v[52:55], v[168:171], v[56:59]
    buffer_load_dwordx4 v[168:171], v4, s[40:43], s55 offen offset:2048 nt
    v_and_b32_dpp v52, v216, v48 row_newbcast:3 row_mask:0xf bank_mask:0xf
    v_and_b32_dpp v53, v216, v49 row_newbcast:3 row_mask:0xf bank_mask:0xf
    v_and_b32_dpp v54, v216, v50 row_newbcast:3 row_mask:0xf bank_mask:0xf
    v_and_b32_dpp v55, v216, v51 row_newbcast:3 row_mask:0xf bank_mask:0xf
    s_waitcnt vmcnt(31)
    v_mfma_f32_16x16x32_bf16 v[56:59], v[212:215], v[172:175], v[56:59]
    buffer_load_dwordx4 v[172:175], v4, s[40:43], s55 offen offset:3072 nt
    v_and_b32_dpp v212, v216, v48 row_newbcast:7 row_mask:0xf bank_mask:0xf
    v_and_b32_dpp v213, v216, v49 row_newbcast:7 row_mask:0xf bank_mask:0xf
    v_and_b32_dpp v214, v216, v50 row_newbcast:7 row_mask:0xf bank_mask:0xf
    v_and_b32_dpp v215, v216, v51 row_newbcast:7 row_mask:0xf bank_mask:0xf
    s_waitcnt vmcnt(31)
    v_mfma_f32_16x16x32_bf16 v[56:59], v[52:55], v[176:179], v[56:59]
    buffer_load_dwordx4 v[176:179], v5, s[40:43], s55 offen offset:0 nt
    v_and_b32_dpp v52, v216, v48 row_newbcast:11 row_mask:0xf bank_mask:0xf
    v_and_b32_dpp v53, v216, v49 row_newbcast:11 row_mask:0xf bank_mask:0xf
    v_and_b32_dpp v54, v216, v50 row_newbcast:11 row_mask:0xf bank_mask:0xf
    v_and_b32_dpp v55, v216, v51 row_newbcast:11 row_mask:0xf bank_mask:0xf
    s_waitcnt vmcnt(31)
    v_mfma_f32_16x16x32_bf16 v[56:59], v[212:215], v[180:183], v[56:59]
    buffer_load_dwordx4 v[180:183], v5, s[40:43], s55 offen offset:1024 nt
    v_and_b32_dpp v212, v216, v48 row_newbcast:15 row_mask:0xf bank_mask:0xf
    v_and_b32_dpp v213, v216, v49 row_newbcast:15 row_mask:0xf bank_mask:0xf
    v_and_b32_dpp v214, v216, v50 row_newbcast:15 row_mask:0xf bank_mask:0xf
    v_and_b32_dpp v215, v216, v51 row_newbcast:15 row_mask:0xf bank_mask:0xf
    s_waitcnt vmcnt(31)
    v_mfma_f32_16x16x32_bf16 v[56:59], v[52:55], v[184:187], v[56:59]
    buffer_load_dwordx4 v[184:187], v5, s[40:43], s55 offen offset:2048 nt
    v_and_b32_dpp v52, v217, v48 row_newbcast:0 row_mask:0xf bank_mask:0xf
    v_and_b32_dpp v53, v217, v49 row_newbcast:0 row_mask:0xf bank_mask:0xf
    v_and_b32_dpp v54, v217, v50 row_newbcast:0 row_mask:0xf bank_mask:0xf
    v_and_b32_dpp v55, v217, v51 row_newbcast:0 row_mask:0xf bank_mask:0xf
    s_waitcnt vmcnt(31)
    v_mfma_f32_16x16x32_bf16 v[56:59], v[212:215], v[188:191], v[56:59]
    buffer_load_dwordx4 v[188:191], v5, s[40:43], s55 offen offset:3072 nt
    v_and_b32_dpp v212, v217, v48 row_newbcast:4 row_mask:0xf bank_mask:0xf
    v_and_b32_dpp v213, v217, v49 row_newbcast:4 row_mask:0xf bank_mask:0xf
    v_and_b32_dpp v214, v217, v50 row_newbcast:4 row_mask:0xf bank_mask:0xf
    v_and_b32_dpp v215, v217, v51 row_newbcast:4 row_mask:0xf bank_mask:0xf
    s_waitcnt vmcnt(31)
    v_mfma_f32_16x16x32_bf16 v[56:59], v[52:55], v[64:67], v[56:59]
    v_and_b32_dpp v52, v217, v48 row_newbcast:8 row_mask:0xf bank_mask:0xf
    v_and_b32_dpp v53, v217, v49 row_newbcast:8 row_mask:0xf bank_mask:0xf
    v_and_b32_dpp v54, v217, v50 row_newbcast:8 row_mask:0xf bank_mask:0xf
    v_and_b32_dpp v55, v217, v51 row_newbcast:8 row_mask:0xf bank_mask:0xf
    s_waitcnt vmcnt(30)
    v_mfma_f32_16x16x32_bf16 v[56:59], v[212:215], v[68:71], v[56:59]
    v_and_b32_dpp v212, v217, v48 row_newbcast:12 row_mask:0xf bank_mask:0xf
    v_and_b32_dpp v213, v217, v49 row_newbcast:12 row_mask:0xf bank_mask:0xf
    v_and_b32_dpp v214, v217, v50 row_newbcast:12 row_mask:0xf bank_mask:0xf
    v_and_b32_dpp v215, v217, v51 row_newbcast:12 row_mask:0xf bank_mask:0xf
    s_waitcnt vmcnt(29)
    v_mfma_f32_16x16x32_bf16 v[56:59], v[52:55], v[72:75], v[56:59]
    v_and_b32_dpp v52, v217, v48 row_newbcast:1 row_mask:0xf bank_mask:0xf
    v_and_b32_dpp v53, v217, v49 row_newbcast:1 row_mask:0xf bank_mask:0xf
    v_and_b32_dpp v54, v217, v50 row_newbcast:1 row_mask:0xf bank_mask:0xf
    v_and_b32_dpp v55, v217, v51 row_newbcast:1 row_mask:0xf bank_mask:0xf
    s_waitcnt vmcnt(28)
    v_mfma_f32_16x16x32_bf16 v[56:59], v[212:215], v[76:79], v[56:59]
    v_and_b32_dpp v212, v217, v48 row_newbcast:5 row_mask:0xf bank_mask:0xf
    v_and_b32_dpp v213, v217, v49 row_newbcast:5 row_mask:0xf bank_mask:0xf
    v_and_b32_dpp v214, v217, v50 row_newbcast:5 row_mask:0xf bank_mask:0xf
    v_and_b32_dpp v215, v217, v51 row_newbcast:5 row_mask:0xf bank_mask:0xf
    s_waitcnt vmcnt(27)
    v_mfma_f32_16x16x32_bf16 v[56:59], v[52:55], v[80:83], v[56:59]
    v_and_b32_dpp v52, v217, v48 row_newbcast:9 row_mask:0xf bank_mask:0xf
    v_and_b32_dpp v53, v217, v49 row_newbcast:9 row_mask:0xf bank_mask:0xf
    v_and_b32_dpp v54, v217, v50 row_newbcast:9 row_mask:0xf bank_mask:0xf
    v_and_b32_dpp v55, v217, v51 row_newbcast:9 row_mask:0xf bank_mask:0xf
    s_waitcnt vmcnt(26)
    v_mfma_f32_16x16x32_bf16 v[56:59], v[212:215], v[84:87], v[56:59]
    v_and_b32_dpp v212, v217, v48 row_newbcast:13 row_mask:0xf bank_mask:0xf
    v_and_b32_dpp v213, v217, v49 row_newbcast:13 row_mask:0xf bank_mask:0xf
    v_and_b32_dpp v214, v217, v50 row_newbcast:13 row_mask:0xf bank_mask:0xf
    v_and_b32_dpp v215, v217, v51 row_newbcast:13 row_mask:0xf bank_mask:0xf
    s_waitcnt vmcnt(25)
    v_mfma_f32_16x16x32_bf16 v[56:59], v[52:55], v[88:91], v[56:59]
    v_and_b32_dpp v52, v217, v48 row_newbcast:2 row_mask:0xf bank_mask:0xf
    v_and_b32_dpp v53, v217, v49 row_newbcast:2 row_mask:0xf bank_mask:0xf
    v_and_b32_dpp v54, v217, v50 row_newbcast:2 row_mask:0xf bank_mask:0xf
    v_and_b32_dpp v55, v217, v51 row_newbcast:2 row_mask:0xf bank_mask:0xf
    s_waitcnt vmcnt(24)
    v_mfma_f32_16x16x32_bf16 v[56:59], v[212:215], v[92:95], v[56:59]
    v_and_b32_dpp v212, v217, v48 row_newbcast:6 row_mask:0xf bank_mask:0xf
    v_and_b32_dpp v213, v217, v49 row_newbcast:6 row_mask:0xf bank_mask:0xf
    v_and_b32_dpp v214, v217, v50 row_newbcast:6 row_mask:0xf bank_mask:0xf
    v_and_b32_dpp v215, v217, v51 row_newbcast:6 row_mask:0xf bank_mask:0xf
    s_waitcnt vmcnt(23)
    v_mfma_f32_16x16x32_bf16 v[56:59], v[52:55], v[96:99], v[56:59]
    v_and_b32_dpp v52, v217, v48 row_newbcast:10 row_mask:0xf bank_mask:0xf
    v_and_b32_dpp v53, v217, v49 row_newbcast:10 row_mask:0xf bank_mask:0xf
    v_and_b32_dpp v54, v217, v50 row_newbcast:10 row_mask:0xf bank_mask:0xf
    v_and_b32_dpp v55, v217, v51 row_newbcast:10 row_mask:0xf bank_mask:0xf
    s_waitcnt vmcnt(22)
    v_mfma_f32_16x16x32_bf16 v[56:59], v[212:215], v[100:103], v[56:59]
    v_and_b32_dpp v212, v217, v48 row_newbcast:14 row_mask:0xf bank_mask:0xf
    v_and_b32_dpp v213, v217, v49 row_newbcast:14 row_mask:0xf bank_mask:0xf
    v_and_b32_dpp v214, v217, v50 row_newbcast:14 row_mask:0xf bank_mask:0xf
    v_and_b32_dpp v215, v217, v51 row_newbcast:14 row_mask:0xf bank_mask:0xf
    s_waitcnt vmcnt(21)
    v_mfma_f32_16x16x32_bf16 v[56:59], v[52:55], v[104:107], v[56:59]
    v_and_b32_dpp v52, v217, v48 row_newbcast:3 row_mask:0xf bank_mask:0xf
    v_and_b32_dpp v53, v217, v49 row_newbcast:3 row_mask:0xf bank_mask:0xf
    v_and_b32_dpp v54, v217, v50 row_newbcast:3 row_mask:0xf bank_mask:0xf
    v_and_b32_dpp v55, v217, v51 row_newbcast:3 row_mask:0xf bank_mask:0xf
    s_waitcnt vmcnt(20)
    v_mfma_f32_16x16x32_bf16 v[56:59], v[212:215], v[108:111], v[56:59]
    v_and_b32_dpp v212, v217, v48 row_newbcast:7 row_mask:0xf bank_mask:0xf
    v_and_b32_dpp v213, v217, v49 row_newbcast:7 row_mask:0xf bank_mask:0xf
    v_and_b32_dpp v214, v217, v50 row_newbcast:7 row_mask:0xf bank_mask:0xf
    v_and_b32_dpp v215, v217, v51 row_newbcast:7 row_mask:0xf bank_mask:0xf
    s_waitcnt vmcnt(19)
    v_mfma_f32_16x16x32_bf16 v[56:59], v[52:55], v[112:115], v[56:59]
    v_and_b32_dpp v52, v217, v48 row_newbcast:11 row_mask:0xf bank_mask:0xf
    v_and_b32_dpp v53, v217, v49 row_newbcast:11 row_mask:0xf bank_mask:0xf
    v_and_b32_dpp v54, v217, v50 row_newbcast:11 row_mask:0xf bank_mask:0xf
    v_and_b32_dpp v55, v217, v51 row_newbcast:11 row_mask:0xf bank_mask:0xf
    s_waitcnt vmcnt(18)
    v_mfma_f32_16x16x32_bf16 v[56:59], v[212:215], v[116:119], v[56:59]
    v_and_b32_dpp v212, v217, v48 row_newbcast:15 row_mask:0xf bank_mask:0xf
    v_and_b32_dpp v213, v217, v49 row_newbcast:15 row_mask:0xf bank_mask:0xf
    v_and_b32_dpp v214, v217, v50 row_newbcast:15 row_mask:0xf bank_mask:0xf
    v_and_b32_dpp v215, v217, v51 row_newbcast:15 row_mask:0xf bank_mask:0xf
    s_waitcnt vmcnt(17)
    v_mfma_f32_16x16x32_bf16 v[56:59], v[52:55], v[120:123], v[56:59]
    v_and_b32_dpp v52, v218, v48 row_newbcast:0 row_mask:0xf bank_mask:0xf
    v_and_b32_dpp v53, v218, v49 row_newbcast:0 row_mask:0xf bank_mask:0xf
    v_and_b32_dpp v54, v218, v50 row_newbcast:0 row_mask:0xf bank_mask:0xf
    v_and_b32_dpp v55, v218, v51 row_newbcast:0 row_mask:0xf bank_mask:0xf
    s_waitcnt vmcnt(16)
    v_mfma_f32_16x16x32_bf16 v[56:59], v[212:215], v[124:127], v[56:59]
    v_and_b32_dpp v212, v218, v48 row_newbcast:4 row_mask:0xf bank_mask:0xf
    v_and_b32_dpp v213, v218, v49 row_newbcast:4 row_mask:0xf bank_mask:0xf
    v_and_b32_dpp v214, v218, v50 row_newbcast:4 row_mask:0xf bank_mask:0xf
    v_and_b32_dpp v215, v218, v51 row_newbcast:4 row_mask:0xf bank_mask:0xf
    s_waitcnt vmcnt(15)
    v_mfma_f32_16x16x32_bf16 v[56:59], v[52:55], v[128:131], v[56:59]
    v_and_b32_dpp v52, v218, v48 row_newbcast:8 row_mask:0xf bank_mask:0xf
    v_and_b32_dpp v53, v218, v49 row_newbcast:8 row_mask:0xf bank_mask:0xf
    v_and_b32_dpp v54, v218, v50 row_newbcast:8 row_mask:0xf bank_mask:0xf
    v_and_b32_dpp v55, v218, v51 row_newbcast:8 row_mask:0xf bank_mask:0xf
    s_waitcnt vmcnt(14)
    v_mfma_f32_16x16x32_bf16 v[56:59], v[212:215], v[132:135], v[56:59]
    v_and_b32_dpp v212, v218, v48 row_newbcast:12 row_mask:0xf bank_mask:0xf
    v_and_b32_dpp v213, v218, v49 row_newbcast:12 row_mask:0xf bank_mask:0xf
    v_and_b32_dpp v214, v218, v50 row_newbcast:12 row_mask:0xf bank_mask:0xf
    v_and_b32_dpp v215, v218, v51 row_newbcast:12 row_mask:0xf bank_mask:0xf
    s_waitcnt vmcnt(13)
    v_mfma_f32_16x16x32_bf16 v[56:59], v[52:55], v[136:139], v[56:59]
    v_and_b32_dpp v52, v218, v48 row_newbcast:1 row_mask:0xf bank_mask:0xf
    v_and_b32_dpp v53, v218, v49 row_newbcast:1 row_mask:0xf bank_mask:0xf
    v_and_b32_dpp v54, v218, v50 row_newbcast:1 row_mask:0xf bank_mask:0xf
    v_and_b32_dpp v55, v218, v51 row_newbcast:1 row_mask:0xf bank_mask:0xf
    s_waitcnt vmcnt(12)
    v_mfma_f32_16x16x32_bf16 v[56:59], v[212:215], v[140:143], v[56:59]
    v_and_b32_dpp v212, v218, v48 row_newbcast:5 row_mask:0xf bank_mask:0xf
    v_and_b32_dpp v213, v218, v49 row_newbcast:5 row_mask:0xf bank_mask:0xf
    v_and_b32_dpp v214, v218, v50 row_newbcast:5 row_mask:0xf bank_mask:0xf
    v_and_b32_dpp v215, v218, v51 row_newbcast:5 row_mask:0xf bank_mask:0xf
    s_waitcnt vmcnt(11)
    v_mfma_f32_16x16x32_bf16 v[56:59], v[52:55], v[144:147], v[56:59]
    v_and_b32_dpp v52, v218, v48 row_newbcast:9 row_mask:0xf bank_mask:0xf
    v_and_b32_dpp v53, v218, v49 row_newbcast:9 row_mask:0xf bank_mask:0xf
    v_and_b32_dpp v54, v218, v50 row_newbcast:9 row_mask:0xf bank_mask:0xf
    v_and_b32_dpp v55, v218, v51 row_newbcast:9 row_mask:0xf bank_mask:0xf
    s_waitcnt vmcnt(10)
    v_mfma_f32_16x16x32_bf16 v[56:59], v[212:215], v[148:151], v[56:59]
    v_and_b32_dpp v212, v218, v48 row_newbcast:13 row_mask:0xf bank_mask:0xf
    v_and_b32_dpp v213, v218, v49 row_newbcast:13 row_mask:0xf bank_mask:0xf
    v_and_b32_dpp v214, v218, v50 row_newbcast:13 row_mask:0xf bank_mask:0xf
    v_and_b32_dpp v215, v218, v51 row_newbcast:13 row_mask:0xf bank_mask:0xf
    s_waitcnt vmcnt(9)
    v_mfma_f32_16x16x32_bf16 v[56:59], v[52:55], v[152:155], v[56:59]
    v_and_b32_dpp v52, v218, v48 row_newbcast:2 row_mask:0xf bank_mask:0xf
    v_and_b32_dpp v53, v218, v49 row_newbcast:2 row_mask:0xf bank_mask:0xf
    v_and_b32_dpp v54, v218, v50 row_newbcast:2 row_mask:0xf bank_mask:0xf
    v_and_b32_dpp v55, v218, v51 row_newbcast:2 row_mask:0xf bank_mask:0xf
    s_waitcnt vmcnt(8)
    v_mfma_f32_16x16x32_bf16 v[56:59], v[212:215], v[156:159], v[56:59]
    v_and_b32_dpp v212, v218, v48 row_newbcast:6 row_mask:0xf bank_mask:0xf
    v_and_b32_dpp v213, v218, v49 row_newbcast:6 row_mask:0xf bank_mask:0xf
    v_and_b32_dpp v214, v218, v50 row_newbcast:6 row_mask:0xf bank_mask:0xf
    v_and_b32_dpp v215, v218, v51 row_newbcast:6 row_mask:0xf bank_mask:0xf
    s_waitcnt vmcnt(7)
    v_mfma_f32_16x16x32_bf16 v[56:59], v[52:55], v[160:163], v[56:59]
    v_and_b32_dpp v52, v218, v48 row_newbcast:10 row_mask:0xf bank_mask:0xf
    v_and_b32_dpp v53, v218, v49 row_newbcast:10 row_mask:0xf bank_mask:0xf
    v_and_b32_dpp v54, v218, v50 row_newbcast:10 row_mask:0xf bank_mask:0xf
    v_and_b32_dpp v55, v218, v51 row_newbcast:10 row_mask:0xf bank_mask:0xf
    s_waitcnt vmcnt(6)
    v_mfma_f32_16x16x32_bf16 v[56:59], v[212:215], v[164:167], v[56:59]
    v_and_b32_dpp v212, v218, v48 row_newbcast:14 row_mask:0xf bank_mask:0xf
    v_and_b32_dpp v213, v218, v49 row_newbcast:14 row_mask:0xf bank_mask:0xf
    v_and_b32_dpp v214, v218, v50 row_newbcast:14 row_mask:0xf bank_mask:0xf
    v_and_b32_dpp v215, v218, v51 row_newbcast:14 row_mask:0xf bank_mask:0xf
    s_waitcnt vmcnt(5)
    v_mfma_f32_16x16x32_bf16 v[56:59], v[52:55], v[168:171], v[56:59]
    v_and_b32_dpp v52, v218, v48 row_newbcast:3 row_mask:0xf bank_mask:0xf
    v_and_b32_dpp v53, v218, v49 row_newbcast:3 row_mask:0xf bank_mask:0xf
    v_and_b32_dpp v54, v218, v50 row_newbcast:3 row_mask:0xf bank_mask:0xf
    v_and_b32_dpp v55, v218, v51 row_newbcast:3 row_mask:0xf bank_mask:0xf
    s_waitcnt vmcnt(4)
    v_mfma_f32_16x16x32_bf16 v[56:59], v[212:215], v[172:175], v[56:59]
    v_and_b32_dpp v212, v218, v48 row_newbcast:7 row_mask:0xf bank_mask:0xf
    v_and_b32_dpp v213, v218, v49 row_newbcast:7 row_mask:0xf bank_mask:0xf
    v_and_b32_dpp v214, v218, v50 row_newbcast:7 row_mask:0xf bank_mask:0xf
    v_and_b32_dpp v215, v218, v51 row_newbcast:7 row_mask:0xf bank_mask:0xf
    s_waitcnt vmcnt(3)
    v_mfma_f32_16x16x32_bf16 v[56:59], v[52:55], v[176:179], v[56:59]
    v_and_b32_dpp v52, v218, v48 row_newbcast:11 row_mask:0xf bank_mask:0xf
    v_and_b32_dpp v53, v218, v49 row_newbcast:11 row_mask:0xf bank_mask:0xf
    v_and_b32_dpp v54, v218, v50 row_newbcast:11 row_mask:0xf bank_mask:0xf
    v_and_b32_dpp v55, v218, v51 row_newbcast:11 row_mask:0xf bank_mask:0xf
    s_waitcnt vmcnt(2)
    v_mfma_f32_16x16x32_bf16 v[56:59], v[212:215], v[180:183], v[56:59]
    v_and_b32_dpp v212, v218, v48 row_newbcast:15 row_mask:0xf bank_mask:0xf
    v_and_b32_dpp v213, v218, v49 row_newbcast:15 row_mask:0xf bank_mask:0xf
    v_and_b32_dpp v214, v218, v50 row_newbcast:15 row_mask:0xf bank_mask:0xf
    v_and_b32_dpp v215, v218, v51 row_newbcast:15 row_mask:0xf bank_mask:0xf
    s_waitcnt vmcnt(1)
    v_mfma_f32_16x16x32_bf16 v[56:59], v[52:55], v[184:187], v[56:59]
    s_nop 0
    s_waitcnt vmcnt(0)
    v_mfma_f32_16x16x32_bf16 v[56:59], v[212:215], v[188:191], v[56:59]
    s_mov_b32 exec_hi, 0
    s_nop 6
    ds_write_b128 v15, v[56:59]
    s_mov_b64 exec, -1
    s_waitcnt lgkmcnt(0)
    s_barrier
    s_cmp_eq_u32 s3, 0
    s_cbranch_scc1 L_final
    s_cmp_lg_u32 s3, 1
    s_cbranch_scc1 L_end
    v_lshlrev_b32 v15, 3, v1
    v_add_u32 v15, 0x22100, v15
    v_mov_b32 v16, 0x22910
    ds_read_b128 v[32:35], v16
    ds_read_b64 v[36:37], v15 offset:0
    ds_read_b64 v[38:39], v15 offset:512
    ds_read_b64 v[40:41], v15 offset:1024
    ds_read_b64 v[42:43], v15 offset:1536
    s_lshl_b32 s54, s46, 8
    s_add_u32 s54, s54, 0x500000
    v_lshlrev_b32 v17, 2, v1
    s_waitcnt lgkmcnt(0)
    v_mul_f32 v15, v32, v36
    v_mul_f32 v16, v32, v37
    v_fmac_f32 v15, v33, v38
    v_fmac_f32 v16, v33, v39
    v_fmac_f32 v15, v34, v40
    v_fmac_f32 v16, v34, v41
    v_fmac_f32 v15, v35, v42
    v_fmac_f32 v16, v35, v43
    v_cvt_pk_bf16_f32 v15, v15, v16
    v_min_u32 v15, 0xfffffffe, v15
    buffer_store_dword v15, v17, s[36:39], s54 offen sc1
    s_lshl_b32 s54, s45, 11
    s_add_u32 s54, s54, 0x500000
    v_lshlrev_b32 v17, 4, v1
    v_lshrrev_b32 v15, 4, v1
    v_lshl_add_u32 v2, v15, 4, v17
    v_add_u32 v2, 0x20800, v2
    s_mov_b64 s[56:57], -1
    s_mov_b64 s[58:59], -1
    s_mov_b32 s55, 0
L_opoll:
    s_mov_b64 exec, s[56:57]
    buffer_load_dwordx4 v[64:67], v17, s[36:39], s54 offen offset:0 sc1
    s_mov_b64 exec, s[58:59]
    buffer_load_dwordx4 v[68:71], v17, s[36:39], s54 offen offset:1024 sc1
    s_mov_b64 exec, -1
    s_add_u32 s55, s55, 1
    s_waitcnt vmcnt(0)
    v_max3_u32 v15, v64, v65, v66
    v_max3_u32 v16, v68, v69, v70
    v_max_u32 v15, v15, v67
    v_max_u32 v16, v16, v71
    v_cmp_eq_u32 s[56:57], -1, v15
    v_cmp_eq_u32 s[58:59], -1, v16
    s_cmp_ge_u32 s55, 0x10000
    s_cbranch_scc1 L_ogo
    s_or_b64 vcc, s[56:57], s[58:59]
    s_cbranch_scc1 L_opoll
L_ogo:
    ds_write_b128 v2, v[64:67]
    ds_write_b128 v2, v[68:71] offset:1088
    s_waitcnt lgkmcnt(0)
    s_barrier
    s_endpgm
L_final:
    v_and_b32 v15, 7, v1
    v_lshlrev_b32 v15, 4, v15
    v_add_u32 v15, 0x22920, v15
    ds_read_b128 v[32:35], v15
    ds_read_b64 v[36:37], v21 offset:128
    s_mul_i32 s54, s44, 0x80000
    s_lshl_b32 s55, s45, 12
    s_add_u32 s54, s54, s55
    s_add_u32 s54, s54, 0x20000
    v_lshlrev_b32 v17, 4, v1
    s_mov_b32 s32, s22
    s_mov_b32 s33, s23
    s_mov_b32 s34, 0x4000
    s_mov_b32 s35, 0x20000
    s_mov_b32 s55, 0
    s_waitcnt vmcnt(0) lgkmcnt(0)
    v_and_b32 v48, 0xfff, v36
    v_bfe_u32 v49, v36, 16, 12
    v_and_b32 v50, 0xfff, v37
    v_bfe_u32 v51, v37, 16, 12
    s_mov_b64 s[56:57], -1
    s_mov_b64 s[58:59], -1
    s_mov_b64 s[60:61], -1
    s_mov_b64 s[62:63], -1
    s_barrier
    s_barrier
L_fpoll:
    s_mov_b64 exec, s[56:57]
    buffer_load_dwordx4 v[64:67], v17, s[36:39], s54 offen offset:0 sc1
    s_mov_b64 exec, s[58:59]
    buffer_load_dwordx4 v[68:71], v17, s[36:39], s54 offen offset:1024 sc1
    s_mov_b64 exec, s[60:61]
    buffer_load_dwordx4 v[72:75], v17, s[36:39], s54 offen offset:2048 sc1
    s_mov_b64 exec, s[62:63]
    buffer_load_dwordx4 v[76:79], v17, s[36:39], s54 offen offset:3072 sc1
    s_mov_b64 exec, -1
    s_add_u32 s55, s55, 1
    s_waitcnt vmcnt(3)
    v_xor_b32 v80, v64, v48
    v_xor_b32 v81, v65, v49
    v_xor_b32 v82, v66, v50
    v_xor_b32 v83, v67, v51
    v_or3_b32 v15, v80, v81, v82
    v_or_b32 v15, v15, v83
    v_and_b32 v15, 0xfff, v15
    v_cmp_ne_u32 s[56:57], 0, v15
    s_waitcnt vmcnt(2)
    v_xor_b32 v84, v68, v48
    v_xor_b32 v85, v69, v49
    v_xor_b32 v86, v70, v50
    v_xor_b32 v87, v71, v51
    v_or3_b32 v15, v84, v85, v86
    v_or_b32 v15, v15, v87
    v_and_b32 v15, 0xfff, v15
    v_cmp_ne_u32 s[58:59], 0, v15
    s_waitcnt vmcnt(1)
    v_xor_b32 v88, v72, v48
    v_xor_b32 v89, v73, v49
    v_xor_b32 v90, v74, v50
    v_xor_b32 v91, v75, v51
    v_or3_b32 v15, v88, v89, v90
    v_or_b32 v15, v15, v91
    v_and_b32 v15, 0xfff, v15
    v_cmp_ne_u32 s[60:61], 0, v15
    s_waitcnt vmcnt(0)
    v_xor_b32 v92, v76, v48
    v_xor_b32 v93, v77, v49
    v_xor_b32 v94, v78, v50
    v_xor_b32 v95, v79, v51
    v_or3_b32 v15, v92, v93, v94
    v_or_b32 v15, v15, v95
    v_and_b32 v15, 0xfff, v15
    v_cmp_ne_u32 s[62:63], 0, v15
    s_cmp_ge_u32 s55, 0x10000
    s_cbranch_scc1 L_fgo
    s_or_b64 vcc, s[56:57], s[58:59]
    s_or_b64 s[50:51], s[60:61], s[62:63]
    s_or_b64 vcc, vcc, s[50:51]
    s_cbranch_scc1 L_fpoll
L_fgo:
    v_add_f32 v80, v80, v84
    v_add_f32 v81, v81, v85
    v_add_f32 v82, v82, v86
    v_add_f32 v83, v83, v87
    v_add_f32 v80, v80, v88
    v_add_f32 v81, v81, v89
    v_add_f32 v82, v82, v90
    v_add_f32 v83, v83, v91
    v_add_f32 v80, v80, v92
    v_add_f32 v81, v81, v93
    v_add_f32 v82, v82, v94
    v_add_f32 v83, v83, v95
    s_nop 1
    v_add_f32_dpp v80, v80, v80 row_ror:8 row_mask:0xf bank_mask:0xf
    v_add_f32_dpp v81, v81, v81 row_ror:8 row_mask:0xf bank_mask:0xf
    v_add_f32_dpp v82, v82, v82 row_ror:8 row_mask:0xf bank_mask:0xf
    v_add_f32_dpp v83, v83, v83 row_ror:8 row_mask:0xf bank_mask:0xf
    v_mov_b32 v84, v80
    v_mov_b32 v85, v81
    v_mov_b32 v86, v82
    v_mov_b32 v87, v83
    s_nop 0
    v_permlane16_swap_b32 v80, v84
    v_permlane16_swap_b32 v81, v85
    v_permlane16_swap_b32 v82, v86
    v_permlane16_swap_b32 v83, v87
    v_add_f32 v80, v80, v84
    v_add_f32 v81, v81, v85
    v_add_f32 v82, v82, v86
    v_add_f32 v83, v83, v87
    v_mov_b32 v84, v80
    v_mov_b32 v85, v81
    v_mov_b32 v86, v82
    v_mov_b32 v87, v83
    s_nop 0
    v_permlane32_swap_b32 v80, v84
    v_permlane32_swap_b32 v81, v85
    v_permlane32_swap_b32 v82, v86
    v_permlane32_swap_b32 v83, v87
    v_add_f32 v80, v80, v84
    v_add_f32 v81, v81, v85
    v_add_f32 v82, v82, v86
    v_add_f32 v83, v83, v87
    s_waitcnt lgkmcnt(0)
    v_add_f32 v80, v32, v80
    v_add_f32 v81, v33, v81
    v_add_f32 v82, v34, v82
    v_add_f32 v83, v35, v83
    v_cvt_pk_bf16_f32 v80, v80, v81
    v_cvt_pk_bf16_f32 v81, v82, v83
    s_lshl_b32 s54, s2, 6
    v_lshlrev_b32 v17, 3, v1
    s_mov_b64 exec, 0xff
    buffer_store_dwordx2 v[80:81], v17, s[32:35], s54 offen
    s_mov_b64 exec, -1
    s_endpgm
L_aux:
    s_sub_u32 s3, s3, 4
    v_mov_b32 v2, 0x229a0
    v_lshrrev_b32 v5, 4, v1
    v_and_b32 v6, 15, v1
    v_and_b32 v7, 7, v1
    v_lshlrev_b32 v10, 4, v1
    v_lshrrev_b32 v3, 5, v1
    v_lshlrev_b32 v3, 11, v3
    v_and_b32 v4, 31, v1
    s_lshl_b32 s49, s3, 12
    v_add_u32 v3, s49, v3
    v_lshl_add_u32 v11, v4, 4, v3
    v_lshrrev_b32 v3, 3, v1
    v_lshlrev_b32 v15, 13, v3
    v_lshl_add_u32 v15, v7, 4, v15
    s_lshl_b32 s50, s48, 21
    s_lshl_b32 s51, s47, 7
    s_add_u32 s50, s50, s51
    s_sub_u32 s51, 0x800000, s50
    s_lshl_b32 s53, s48, 9
    s_lshl_b32 s54, s3, 13
    s_add_u32 m0, s54, 0x0
    s_lshl_b32 s55, s3, 19
    s_memrealtime s[62:63]
    v_lshrrev_b32 v3, 3, v6
    v_lshlrev_b32 v8, 6, v3
    v_lshl_add_u32 v8, v5, 4, v8
    v_lshl_add_u32 v8, v7, 19, v8
    v_mov_b32 v4, 0
    s_xor_b32 s60, s3, 3
    s_or_b32 s60, s60, s2
    s_waitcnt lgkmcnt(0)
    s_mov_b32 s40, s24
    s_mov_b32 s41, s25
    s_mov_b32 s42, 0x100
    s_mov_b32 s43, 0x20000
    s_mov_b32 s36, s26
    s_mov_b32 s37, s27
    s_mov_b32 s38, 0x600000
    s_mov_b32 s39, 0x20000
    s_cmp_lg_u32 s60, 0
    s_cbranch_scc1 L_a_noz
    s_lshl_b32 s56, s62, 1
    s_or_b32 s56, s56, 1
    s_and_b32 s56, s56, 0xfff
    s_bfe_u32 s57, s62, 0xb000b
    s_lshl_b32 s57, s57, 17
    s_or_b32 s56, s56, s57
    s_lshr_b64 s[62:63], s[62:63], 22
    s_and_b32 s57, s62, 0xfff
    s_bfe_u32 s62, s62, 0xc000c
    s_lshl_b32 s62, s62, 16
    s_or_b32 s57, s57, s62
    s_or_b32 s57, s57, 0x80000000
    v_mov_b32 v64, s56
    v_mov_b32 v65, s57
    s_mov_b64 exec, 1
    buffer_store_dwordx2 v[64:65], v4, s[40:43], 0 offen sc1
    s_mov_b64 exec, -1
    v_lshrrev_b32 v3, 2, v1
    v_lshlrev_b32 v3, 8, v3
    v_and_b32 v32, 3, v1
    v_lshl_add_u32 v3, v32, 13, v3
    s_mov_b32 s56, 0x540000
    buffer_store_dword v4, v3, s[36:39], s56 offen sc1
L_a_noz:
    s_mov_b32 s28, s4
    s_mov_b32 s29, s5
    s_mov_b32 s30, 0x4000
    s_mov_b32 s31, 0x20000
    s_add_u32 s32, s10, s50
    s_addc_u32 s33, s11, 0
    s_mov_b32 s34, s51
    s_mov_b32 s35, 0x20000
    buffer_load_dwordx4 v[16:19], v11, s[28:31], 0 offen offset:0
    buffer_load_dwordx4 v[20:23], v11, s[28:31], 0 offen offset:512
    buffer_load_dwordx4 v[24:27], v11, s[28:31], 0 offen offset:1024
    buffer_load_dwordx4 v[28:31], v11, s[28:31], 0 offen offset:1536
    buffer_load_dwordx4 v[68:71], v11, s[28:31], s53 offen
    buffer_load_dwordx4 v15, s[32:35], s55 offen nt lds
    s_add_u32 m0, m0, 0x400
    s_add_u32 s55, s55, 0x10000
    s_nop 0
    buffer_load_dwordx4 v15, s[32:35], s55 offen nt lds
    s_add_u32 m0, m0, 0x400
    s_add_u32 s55, s55, 0x10000
    s_nop 0
    buffer_load_dwordx4 v15, s[32:35], s55 offen nt lds
    s_add_u32 m0, m0, 0x400
    s_add_u32 s55, s55, 0x10000
    s_nop 0
    buffer_load_dwordx4 v15, s[32:35], s55 offen nt lds
    s_add_u32 m0, m0, 0x400
    s_add_u32 s55, s55, 0x10000
    s_nop 0
    buffer_load_dwordx4 v15, s[32:35], s55 offen nt lds
    s_add_u32 m0, m0, 0x400
    s_add_u32 s55, s55, 0x10000
    s_nop 0
    buffer_load_dwordx4 v15, s[32:35], s55 offen nt lds
    s_add_u32 m0, m0, 0x400
    s_add_u32 s55, s55, 0x10000
    s_nop 0
    buffer_load_dwordx4 v15, s[32:35], s55 offen nt lds
    s_add_u32 m0, m0, 0x400
    s_add_u32 s55, s55, 0x10000
    s_nop 0
    buffer_load_dwordx4 v15, s[32:35], s55 offen nt lds
    s_barrier
    s_cmp_lg_u32 s3, 2
    s_cbranch_scc1 L_a_nocl
    v_mov_b32 v32, -1
    v_mov_b32 v33, -1
    v_mov_b32 v34, -1
    v_mov_b32 v35, -1
    s_lshl_b32 s54, s46, 8
    s_add_u32 s54, s54, 0x500000
    s_mov_b64 exec, 0xffff
    buffer_store_dwordx4 v[32:35], v10, s[36:39], s54 offen sc1
    s_mov_b64 exec, -1
    s_nop 0
L_a_nocl:
    s_lshl_b32 s61, s44, 14
    s_lshl_b32 s55, s3, 12
    s_add_u32 s61, s61, s55
    s_lshl_b32 s55, s45, 7
    s_add_u32 s61, s61, s55
    s_add_u32 s61, s61, 0x20000
    s_waitcnt vmcnt(9)
    v_lshlrev_b32 v32, 16, v16
    v_and_b32 v33, 0xffff0000, v16
    v_lshlrev_b32 v34, 16, v17
    v_and_b32 v35, 0xffff0000, v17
    v_lshlrev_b32 v36, 16, v18
    v_and_b32 v37, 0xffff0000, v18
    v_lshlrev_b32 v38, 16, v19
    v_and_b32 v39, 0xffff0000, v19
    v_lshlrev_b32 v40, 16, v20
    v_and_b32 v41, 0xffff0000, v20
    v_lshlrev_b32 v42, 16, v21
    v_and_b32 v43, 0xffff0000, v21
    v_lshlrev_b32 v44, 16, v22
    v_and_b32 v45, 0xffff0000, v22
    v_lshlrev_b32 v46, 16, v23
    v_and_b32 v47, 0xffff0000, v23
    v_lshlrev_b32 v48, 16, v24
    v_and_b32 v49, 0xffff0000, v24
    v_lshlrev_b32 v50, 16, v25
    v_and_b32 v51, 0xffff0000, v25
    v_lshlrev_b32 v52, 16, v26
    v_and_b32 v53, 0xffff0000, v26
    v_lshlrev_b32 v54, 16, v27
    v_and_b32 v55, 0xffff0000, v27
    v_lshlrev_b32 v56, 16, v28
    v_and_b32 v57, 0xffff0000, v28
    v_lshlrev_b32 v58, 16, v29
    v_and_b32 v59, 0xffff0000, v29
    v_lshlrev_b32 v60, 16, v30
    v_and_b32 v61, 0xffff0000, v30
    v_lshlrev_b32 v62, 16, v31
    v_and_b32 v63, 0xffff0000, v31
    v_pk_add_f32 v[12:13], v[32:33], v[34:35]
    v_pk_add_f32 v[14:15], v[36:37], v[38:39]
    v_pk_add_f32 v[12:13], v[12:13], v[40:41]
    v_pk_add_f32 v[14:15], v[14:15], v[42:43]
    v_pk_add_f32 v[12:13], v[12:13], v[44:45]
    v_pk_add_f32 v[14:15], v[14:15], v[46:47]
    v_pk_add_f32 v[12:13], v[12:13], v[48:49]
    v_pk_add_f32 v[14:15], v[14:15], v[50:51]
    v_pk_add_f32 v[12:13], v[12:13], v[52:53]
    v_pk_add_f32 v[14:15], v[14:15], v[54:55]
    v_pk_add_f32 v[12:13], v[12:13], v[56:57]
    v_pk_add_f32 v[14:15], v[14:15], v[58:59]
    v_pk_add_f32 v[12:13], v[12:13], v[60:61]
    v_pk_add_f32 v[14:15], v[14:15], v[62:63]
    v_pk_add_f32 v[12:13], v[12:13], v[14:15]
    v_add_f32 v12, v12, v13
    s_nop 1
    v_add_f32_dpp v12, v12, v12 row_ror:8 row_mask:0xf bank_mask:0xf
    s_nop 1
    v_add_f32_dpp v12, v12, v12 row_ror:4 row_mask:0xf bank_mask:0xf
    s_nop 1
    v_add_f32_dpp v12, v12, v12 row_ror:2 row_mask:0xf bank_mask:0xf
    s_nop 1
    v_add_f32_dpp v12, v12, v12 row_ror:1 row_mask:0xf bank_mask:0xf
    v_mov_b32 v3, v12
    s_nop 1
    v_permlane16_swap_b32 v12, v3
    s_nop 0
    v_add_f32 v12, v12, v3
    v_mul_f32 v16, 0xba800000, v12
    v_mov_b32 v17, v16
    v_pk_add_f32 v[32:33], v[32:33], v[16:17]
    v_pk_add_f32 v[34:35], v[34:35], v[16:17]
    v_pk_add_f32 v[36:37], v[36:37], v[16:17]
    v_pk_add_f32 v[38:39], v[38:39], v[16:17]
    v_pk_add_f32 v[40:41], v[40:41], v[16:17]
    v_pk_add_f32 v[42:43], v[42:43], v[16:17]
    v_pk_add_f32 v[44:45], v[44:45], v[16:17]
    v_pk_add_f32 v[46:47], v[46:47], v[16:17]
    v_pk_add_f32 v[48:49], v[48:49], v[16:17]
    v_pk_add_f32 v[50:51], v[50:51], v[16:17]
    v_pk_add_f32 v[52:53], v[52:53], v[16:17]
    v_pk_add_f32 v[54:55], v[54:55], v[16:17]
    v_pk_add_f32 v[56:57], v[56:57], v[16:17]
    v_pk_add_f32 v[58:59], v[58:59], v[16:17]
    v_pk_add_f32 v[60:61], v[60:61], v[16:17]
    v_pk_add_f32 v[62:63], v[62:63], v[16:17]
    v_pk_mul_f32 v[12:13], v[32:33], v[32:33]
    v_pk_mul_f32 v[14:15], v[34:35], v[34:35]
    v_pk_fma_f32 v[12:13], v[36:37], v[36:37], v[12:13]
    v_pk_fma_f32 v[14:15], v[38:39], v[38:39], v[14:15]
    v_pk_fma_f32 v[12:13], v[40:41], v[40:41], v[12:13]
    v_pk_fma_f32 v[14:15], v[42:43], v[42:43], v[14:15]
    v_pk_fma_f32 v[12:13], v[44:45], v[44:45], v[12:13]
    v_pk_fma_f32 v[14:15], v[46:47], v[46:47], v[14:15]
    v_pk_fma_f32 v[12:13], v[48:49], v[48:49], v[12:13]
    v_pk_fma_f32 v[14:15], v[50:51], v[50:51], v[14:15]
    v_pk_fma_f32 v[12:13], v[52:53], v[52:53], v[12:13]
    v_pk_fma_f32 v[14:15], v[54:55], v[54:55], v[14:15]
    v_pk_fma_f32 v[12:13], v[56:57], v[56:57], v[12:13]
    v_pk_fma_f32 v[14:15], v[58:59], v[58:59], v[14:15]
    v_pk_fma_f32 v[12:13], v[60:61], v[60:61], v[12:13]
    v_pk_fma_f32 v[14:15], v[62:63], v[62:63], v[14:15]
    v_pk_add_f32 v[12:13], v[12:13], v[14:15]
    v_add_f32 v12, v12, v13
    s_nop 1
    v_add_f32_dpp v12, v12, v12 row_ror:8 row_mask:0xf bank_mask:0xf
    s_nop 1
    v_add_f32_dpp v12, v12, v12 row_ror:4 row_mask:0xf bank_mask:0xf
    s_nop 1
    v_add_f32_dpp v12, v12, v12 row_ror:2 row_mask:0xf bank_mask:0xf
    s_nop 1
    v_add_f32_dpp v12, v12, v12 row_ror:1 row_mask:0xf bank_mask:0xf
    v_mov_b32 v3, v12
    s_nop 1
    v_permlane16_swap_b32 v12, v3
    s_nop 0
    v_add_f32 v12, v12, v3
    v_mul_f32 v12, 0x3a800000, v12
    v_cvt_pk_bf16_f32 v12, v12, v12
    v_and_b32 v12, 0xffff0000, v12
    v_add_f32 v12, 0x3727c5ac, v12
    v_cvt_pk_bf16_f32 v12, v12, v12
    v_and_b32 v12, 0xffff0000, v12
    v_sqrt_f32 v12, v12
    s_nop 0
    v_cvt_pk_bf16_f32 v12, v12, v12
    v_and_b32 v12, 0xffff0000, v12
    v_rcp_f32 v13, v12
    v_cvt_pk_bf16_f32 v16, v16, v16
    v_and_b32 v16, 0xffff0000, v16
    s_waitcnt vmcnt(8)
    s_cmp_lg_u32 s3, 3
    s_cbranch_scc1 L_a_nn1
    buffer_load_dwordx2 v[28:29], v4, s[40:43], 0 offen sc1
L_a_nn1:
    v_lshlrev_b32 v32, 16, v68
    v_and_b32 v33, 0xffff0000, v68
    v_add_f32 v32, v32, v16
    v_add_f32 v33, v33, v16
    v_cvt_pk_bf16_f32 v33, v32, v33
    v_lshlrev_b32 v32, 16, v33
    v_and_b32 v33, 0xffff0000, v33
    v_mul_f32 v34, v32, v13
    v_mul_f32 v35, v33, v13
    v_fma_f32 v32, -v34, v12, v32
    v_fma_f32 v33, -v35, v12, v33
    v_fmac_f32 v34, v32, v13
    v_fmac_f32 v35, v33, v13
    v_cvt_pk_bf16_f32 v68, v34, v35
    v_lshlrev_b32 v32, 16, v69
    v_and_b32 v33, 0xffff0000, v69
    v_add_f32 v32, v32, v16
    v_add_f32 v33, v33, v16
    v_cvt_pk_bf16_f32 v33, v32, v33
    v_lshlrev_b32 v32, 16, v33
    v_and_b32 v33, 0xffff0000, v33
    v_mul_f32 v34, v32, v13
    v_mul_f32 v35, v33, v13
    v_fma_f32 v32, -v34, v12, v32
    v_fma_f32 v33, -v35, v12, v33
    v_fmac_f32 v34, v32, v13
    v_fmac_f32 v35, v33, v13
    v_cvt_pk_bf16_f32 v69, v34, v35
    v_lshlrev_b32 v32, 16, v70
    v_and_b32 v33, 0xffff0000, v70
    v_add_f32 v32, v32, v16
    v_add_f32 v33, v33, v16
    v_cvt_pk_bf16_f32 v33, v32, v33
    v_lshlrev_b32 v32, 16, v33
    v_and_b32 v33, 0xffff0000, v33
    v_mul_f32 v34, v32, v13
    v_mul_f32 v35, v33, v13
    v_fma_f32 v32, -v34, v12, v32
    v_fma_f32 v33, -v35, v12, v33
    v_fmac_f32 v34, v32, v13
    v_fmac_f32 v35, v33, v13
    v_cvt_pk_bf16_f32 v70, v34, v35
    v_lshlrev_b32 v32, 16, v71
    v_and_b32 v33, 0xffff0000, v71
    v_add_f32 v32, v32, v16
    v_add_f32 v33, v33, v16
    v_cvt_pk_bf16_f32 v33, v32, v33
    v_lshlrev_b32 v32, 16, v33
    v_and_b32 v33, 0xffff0000, v33
    v_mul_f32 v34, v32, v13
    v_mul_f32 v35, v33, v13
    v_fma_f32 v32, -v34, v12, v32
    v_fma_f32 v33, -v35, v12, v33
    v_fmac_f32 v34, v32, v13
    v_fmac_f32 v35, v33, v13
    v_cvt_pk_bf16_f32 v71, v34, v35
    s_lshl_b32 s54, s3, 10
    s_add_u32 s54, s54, 0x20800
    v_add_u32 v3, s54, v10
    ds_write_b128 v3, v[68:71]
    v_bfe_u32 v3, v1, 2, 2
    v_lshl_add_u32 v11, v5, 3, v3
    v_and_b32 v13, 3, v1
    v_lshlrev_b32 v13, 3, v13
    v_lshl_add_u32 v9, v11, 8, v13
    s_lshl_b32 s54, s3, 6
    v_add_u32 v9, s54, v9
    v_lshl_add_u32 v15, v11, 7, v13
    v_add_u32 v15, s54, v15
    s_mov_b32 s58, 0xff00ff00
    s_mov_b32 s59, 0xff00ff00
    s_mov_b32 s100, 0
    s_mov_b32 s101, -1
    s_mov_b32 s49, 0xfffff000
    v_lshlrev_b32 v14, 9, v7
    v_lshl_add_u32 v14, v5, 4, v14
    v_add_u32 v14, 0x20800, v14
    s_waitcnt vmcnt(0)
    s_cmp_lg_u32 s3, 3
    s_cbranch_scc1 L_a_nn2
    s_mov_b32 s57, 0
L_npoll:
    v_readfirstlane_b32 s56, v29
    s_cmp_lg_u32 s56, 0
    s_cbranch_scc1 L_ngo
    buffer_load_dwordx2 v[28:29], v4, s[40:43], 0 offen sc1
    s_add_u32 s57, s57, 1
    s_waitcnt vmcnt(0)
    s_cmp_lt_u32 s57, 0x10000
    s_cbranch_scc1 L_npoll
L_ngo:
    ds_write_b64 v2, v[28:29] offset:128
L_a_nn2:
    s_mov_b64 exec, 1
    v_mov_b32 v3, 1
    ds_add_rtn_u32 v3, v2, v3 offset:0
    s_waitcnt lgkmcnt(0)
    v_readfirstlane_b32 s56, v3
    s_mov_b64 exec, -1
    s_mov_b32 s57, 0
L_w_173:
    ds_read_b32 v3, v2 offset:0
    s_waitcnt lgkmcnt(0)
    v_readfirstlane_b32 s56, v3
    s_cmp_ge_u32 s56, 4
    s_cbranch_scc1 L_wd_174
    s_add_u32 s57, s57, 1
    s_cmp_lt_u32 s57, 0x100000
    s_cbranch_scc1 L_w_173
L_wd_174:
    ds_read_b64 v[28:29], v2 offset:128
    ds_read_b128 v[80:83], v14 offset:0
    ds_read_b128 v[84:87], v14 offset:64
    ds_read_b128 v[88:91], v14 offset:128
    ds_read_b128 v[92:95], v14 offset:192
    ds_read_b128 v[96:99], v14 offset:256
    ds_read_b128 v[100:103], v14 offset:320
    ds_read_b128 v[104:107], v14 offset:384
    ds_read_b128 v[108:111], v14 offset:448
    s_waitcnt lgkmcnt(0)
    v_and_b32 v64, 0xfff, v28
    v_bfe_u32 v65, v28, 16, 12
    v_and_b32 v66, 0xfff, v29
    v_bfe_u32 v67, v29, 16, 12
    s_mov_b32 s60, 0xffffff00
    s_mov_b32 s50, 0xaaaaaaaa
    s_mov_b32 s51, 0xaaaaaaaa
    s_mov_b32 s52, 0xffff0000
    s_mov_b32 s53, 0xffff0000
    v_cndmask_b32 v23, v28, v29, s[50:51]
    v_cndmask_b32 v27, v28, v29, s[52:53]
    v_and_b32 v20, 0xff, v23
    v_bfe_u32 v21, v23, 8, 8
    v_bfe_u32 v22, v23, 16, 8
    v_lshrrev_b32 v23, 24, v23
    v_and_b32 v24, 0xff, v27
    v_bfe_u32 v25, v27, 8, 8
    v_bfe_u32 v26, v27, 16, 8
    v_lshrrev_b32 v27, 24, v27
    s_cmp_ge_u32 s3, 2
    s_cbranch_scc1 L_a_b1
    ds_read_b64_tr_b16 v[112:113], v15 offset:0
    ds_read_b64_tr_b16 v[114:115], v15 offset:512
    ds_read_b64_tr_b16 v[116:117], v15 offset:4096
    ds_read_b64_tr_b16 v[118:119], v15 offset:4608
    ds_read_b64_tr_b16 v[120:121], v15 offset:8192
    ds_read_b64_tr_b16 v[122:123], v15 offset:8704
    ds_read_b64_tr_b16 v[124:125], v15 offset:12288
    ds_read_b64_tr_b16 v[126:127], v15 offset:12800
    s_waitcnt lgkmcnt(0)
    ds_read_b64_tr_b16 v[128:129], v15 offset:16384
    ds_read_b64_tr_b16 v[130:131], v15 offset:16896
    ds_read_b64_tr_b16 v[132:133], v15 offset:20480
    ds_read_b64_tr_b16 v[134:135], v15 offset:20992
    ds_read_b64_tr_b16 v[136:137], v15 offset:24576
    ds_read_b64_tr_b16 v[138:139], v15 offset:25088
    ds_read_b64_tr_b16 v[140:141], v15 offset:28672
    ds_read_b64_tr_b16 v[142:143], v15 offset:29184
    s_waitcnt lgkmcnt(0)
    ds_read_b64_tr_b16 v[144:145], v15 offset:32
    ds_read_b64_tr_b16 v[146:147], v15 offset:544
    ds_read_b64_tr_b16 v[148:149], v15 offset:4128
    ds_read_b64_tr_b16 v[150:151], v15 offset:4640
    ds_read_b64_tr_b16 v[152:153], v15 offset:8224
    ds_read_b64_tr_b16 v[154:155], v15 offset:8736
    ds_read_b64_tr_b16 v[156:157], v15 offset:12320
    ds_read_b64_tr_b16 v[158:159], v15 offset:12832
    s_waitcnt lgkmcnt(0)
    ds_read_b64_tr_b16 v[160:161], v15 offset:16416
    ds_read_b64_tr_b16 v[162:163], v15 offset:16928
    ds_read_b64_tr_b16 v[164:165], v15 offset:20512
    ds_read_b64_tr_b16 v[166:167], v15 offset:21024
    ds_read_b64_tr_b16 v[168:169], v15 offset:24608
    ds_read_b64_tr_b16 v[170:171], v15 offset:25120
    ds_read_b64_tr_b16 v[172:173], v15 offset:28704
    ds_read_b64_tr_b16 v[174:175], v15 offset:29216
    s_waitcnt lgkmcnt(0)
    v_mfma_f32_16x16x32_bf16 v[72:75], v[112:115], v[80:83], 0
    v_mfma_f32_16x16x32_bf16 v[76:79], v[144:147], v[80:83], 0
    v_mfma_f32_16x16x32_bf16 v[72:75], v[116:119], v[84:87], v[72:75]
    v_mfma_f32_16x16x32_bf16 v[76:79], v[148:151], v[84:87], v[76:79]
    v_mfma_f32_16x16x32_bf16 v[72:75], v[120:123], v[88:91], v[72:75]
    v_mfma_f32_16x16x32_bf16 v[76:79], v[152:155], v[88:91], v[76:79]
    v_mfma_f32_16x16x32_bf16 v[72:75], v[124:127], v[92:95], v[72:75]
    v_mfma_f32_16x16x32_bf16 v[76:79], v[156:159], v[92:95], v[76:79]
    v_mfma_f32_16x16x32_bf16 v[72:75], v[128:131], v[96:99], v[72:75]
    v_mfma_f32_16x16x32_bf16 v[76:79], v[160:163], v[96:99], v[76:79]
    v_mfma_f32_16x16x32_bf16 v[72:75], v[132:135], v[100:103], v[72:75]
    v_mfma_f32_16x16x32_bf16 v[76:79], v[164:167], v[100:103], v[76:79]
    v_mfma_f32_16x16x32_bf16 v[72:75], v[136:139], v[104:107], v[72:75]
    v_mfma_f32_16x16x32_bf16 v[76:79], v[168:171], v[104:107], v[76:79]
    v_mfma_f32_16x16x32_bf16 v[72:75], v[140:143], v[108:111], v[72:75]
    v_mfma_f32_16x16x32_bf16 v[76:79], v[172:175], v[108:111], v[76:79]
    s_nop 7
    v_cndmask_b32 v72, v72, v76, s[58:59]
    v_cndmask_b32 v73, v73, v77, s[58:59]
    v_cndmask_b32 v74, v74, v78, s[58:59]
    v_cndmask_b32 v75, v75, v79, s[58:59]
    v_add_u32 v72, 0x80, v72
    v_add_u32 v73, 0x80, v73
    v_add_u32 v74, 0x80, v74
    v_add_u32 v75, 0x80, v75
    v_and_or_b32 v72, v72, s60, v24
    v_and_or_b32 v73, v73, s60, v25
    v_and_or_b32 v74, v74, s60, v26
    v_and_or_b32 v75, v75, s60, v27
    s_lshl_b32 s54, s46, 8
    s_lshl_b32 s55, s3, 7
    s_add_u32 s54, s54, s55
    buffer_store_dwordx4 v[72:75], v8, s[36:39], s54 offen nt sc1
    s_cmp_lg_u32 s3, 0
    s_cbranch_scc1 L_a_b1
    s_mul_i32 s54, s44, 0x80000
    s_lshl_b32 s55, s45, 11
    s_add_u32 s54, s54, s55
    s_mov_b32 s57, 0
L_w_175:
    ds_read_b32 v3, v2 offset:48
    s_waitcnt lgkmcnt(0)
    v_readfirstlane_b32 s56, v3
    s_cmp_ge_u32 s56, 1
    s_cbranch_scc1 L_wd_176
    s_sleep 2
    s_add_u32 s57, s57, 1
    s_cmp_lt_u32 s57, 0x100000
    s_cbranch_scc1 L_w_175
L_wd_176:
    s_mov_b32 s57, 0
L_qpoll:
    buffer_load_dwordx4 v[32:35], v10, s[36:39], s54 offen offset:0 nt sc1
    buffer_load_dwordx4 v[36:39], v10, s[36:39], s54 offen offset:1024 nt sc1
    s_add_u32 s57, s57, 1
    s_waitcnt vmcnt(0)
    v_xor_b32 v32, v32, v20
    v_xor_b32 v33, v33, v21
    v_xor_b32 v34, v34, v22
    v_xor_b32 v35, v35, v23
    v_xor_b32 v36, v36, v20
    v_xor_b32 v37, v37, v21
    v_xor_b32 v38, v38, v22
    v_xor_b32 v39, v39, v23
    v_or3_b32 v3, v32, v33, v34
    v_or3_b32 v4, v35, v36, v37
    v_or3_b32 v3, v3, v38, v39
    v_or_b32 v3, v3, v4
    v_and_b32 v3, 0xff, v3
    v_cmp_ne_u32 vcc, 0, v3
    s_cbranch_vccz L_qpoll_go
    s_cmp_lt_u32 s57, 0x10000
    s_cbranch_scc1 L_qpoll
L_qpoll_go:
    v_permlane32_swap_b32 v32, v36
    v_permlane32_swap_b32 v33, v37
    v_permlane32_swap_b32 v34, v38
    v_permlane32_swap_b32 v35, v39
    v_add_f32 v32, v32, v36
    v_add_f32 v33, v33, v37
    v_add_f32 v34, v34, v38
    v_add_f32 v35, v35, v39
    v_mov_b32 v36, v32
    v_mov_b32 v37, v33
    v_mov_b32 v38, v34
    v_mov_b32 v39, v35
    v_lshrrev_b32 v3, 5, v1
    v_lshlrev_b32 v3, 7, v3
    v_lshl_add_u32 v3, v6, 3, v3
    v_add_u32 v3, 0x21800, v3
    v_permlane16_swap_b32 v32, v36
    v_permlane16_swap_b32 v33, v37
    v_permlane16_swap_b32 v34, v38
    v_permlane16_swap_b32 v35, v39
    v_add_f32 v32, v32, v36
    v_add_f32 v33, v33, v37
    v_add_f32 v34, v34, v38
    v_add_f32 v35, v35, v39
    v_cvt_pk_bf16_f32 v32, v32, v33
    v_cvt_pk_bf16_f32 v33, v34, v35
    ds_write_b64 v3, v[32:33]
L_a_b1:
    s_lshl_b32 s54, s3, 5
    s_sub_u32 s54, 0x8000, s54
    v_add_u32 v15, s54, v15
    s_waitcnt lgkmcnt(0)
    s_barrier
    s_cmp_ge_u32 s46, 224
    s_cbranch_scc1 L_a_s1done
    ds_read_b64_tr_b16 v[112:113], v15 offset:0
    ds_read_b64_tr_b16 v[114:115], v15 offset:512
    ds_read_b64_tr_b16 v[116:117], v15 offset:4096
    ds_read_b64_tr_b16 v[118:119], v15 offset:4608
    ds_read_b64_tr_b16 v[120:121], v15 offset:8192
    ds_read_b64_tr_b16 v[122:123], v15 offset:8704
    ds_read_b64_tr_b16 v[124:125], v15 offset:12288
    ds_read_b64_tr_b16 v[126:127], v15 offset:12800
    s_waitcnt lgkmcnt(0)
    ds_read_b64_tr_b16 v[128:129], v15 offset:16384
    ds_read_b64_tr_b16 v[130:131], v15 offset:16896
    ds_read_b64_tr_b16 v[132:133], v15 offset:20480
    ds_read_b64_tr_b16 v[134:135], v15 offset:20992
    ds_read_b64_tr_b16 v[136:137], v15 offset:24576
    ds_read_b64_tr_b16 v[138:139], v15 offset:25088
    ds_read_b64_tr_b16 v[140:141], v15 offset:28672
    ds_read_b64_tr_b16 v[142:143], v15 offset:29184
    s_waitcnt lgkmcnt(0)
    ds_read_b64_tr_b16 v[144:145], v15 offset:32768
    ds_read_b64_tr_b16 v[146:147], v15 offset:33280
    ds_read_b64_tr_b16 v[148:149], v15 offset:36864
    ds_read_b64_tr_b16 v[150:151], v15 offset:37376
    ds_read_b64_tr_b16 v[152:153], v15 offset:40960
    ds_read_b64_tr_b16 v[154:155], v15 offset:41472
    ds_read_b64_tr_b16 v[156:157], v15 offset:45056
    ds_read_b64_tr_b16 v[158:159], v15 offset:45568
    s_waitcnt lgkmcnt(0)
    ds_read_b64_tr_b16 v[160:161], v15 offset:49152
    ds_read_b64_tr_b16 v[162:163], v15 offset:49664
    ds_read_b64_tr_b16 v[164:165], v15 offset:53248
    ds_read_b64_tr_b16 v[166:167], v15 offset:53760
    ds_read_b64_tr_b16 v[168:169], v15 offset:57344
    ds_read_b64_tr_b16 v[170:171], v15 offset:57856
    ds_read_b64_tr_b16 v[172:173], v15 offset:61440
    ds_read_b64_tr_b16 v[174:175], v15 offset:61952
    s_waitcnt lgkmcnt(0)
    v_mfma_f32_16x16x32_bf16 v[72:75], v[112:115], v[80:83], 0
    v_mfma_f32_16x16x32_bf16 v[76:79], v[144:147], v[80:83], 0
    v_mfma_f32_16x16x32_bf16 v[72:75], v[116:119], v[84:87], v[72:75]
    v_mfma_f32_16x16x32_bf16 v[76:79], v[148:151], v[84:87], v[76:79]
    v_mfma_f32_16x16x32_bf16 v[72:75], v[120:123], v[88:91], v[72:75]
    v_mfma_f32_16x16x32_bf16 v[76:79], v[152:155], v[88:91], v[76:79]
    v_mfma_f32_16x16x32_bf16 v[72:75], v[124:127], v[92:95], v[72:75]
    v_mfma_f32_16x16x32_bf16 v[76:79], v[156:159], v[92:95], v[76:79]
    v_mfma_f32_16x16x32_bf16 v[72:75], v[128:131], v[96:99], v[72:75]
    v_mfma_f32_16x16x32_bf16 v[76:79], v[160:163], v[96:99], v[76:79]
    v_mfma_f32_16x16x32_bf16 v[72:75], v[132:135], v[100:103], v[72:75]
    v_mfma_f32_16x16x32_bf16 v[76:79], v[164:167], v[100:103], v[76:79]
    v_mfma_f32_16x16x32_bf16 v[72:75], v[136:139], v[104:107], v[72:75]
    v_mfma_f32_16x16x32_bf16 v[76:79], v[168:171], v[104:107], v[76:79]
    v_mfma_f32_16x16x32_bf16 v[72:75], v[140:143], v[108:111], v[72:75]
    v_mfma_f32_16x16x32_bf16 v[76:79], v[172:175], v[108:111], v[76:79]
    s_nop 7
    v_cndmask_b32 v72, v72, v76, s[58:59]
    v_cndmask_b32 v73, v73, v77, s[58:59]
    v_cndmask_b32 v74, v74, v78, s[58:59]
    v_cndmask_b32 v75, v75, v79, s[58:59]
    v_add_u32 v72, 0x80, v72
    v_add_u32 v73, 0x80, v73
    v_add_u32 v74, 0x80, v74
    v_add_u32 v75, 0x80, v75
    v_and_or_b32 v72, v72, s60, v20
    v_and_or_b32 v73, v73, s60, v21
    v_and_or_b32 v74, v74, s60, v22
    v_and_or_b32 v75, v75, s60, v23
    s_lshl_b32 s54, s46, 12
    s_lshl_b32 s55, s3, 10
    s_add_u32 s54, s54, s55
    s_add_u32 s54, s54, 0x400000
    s_cmp_eq_u32 s3, s48
    s_cbranch_scc1 L_a_guown
    buffer_store_dwordx4 v[72:75], v10, s[36:39], s54 offen nt sc1
    s_branch L_a_s1done
L_a_guown:
    v_add_u32 v3, 0x20000, v10
    ds_write_b128 v3, v[72:75]
L_a_s1done:
    s_cmp_lg_u32 s3, 3
    s_cbranch_scc1 L_a_notouch
    v_mov_b32 v3, 0
    s_mov_b64 exec, 1
    s_mov_b32 s32, s12
    s_mov_b32 s33, s13
    s_mov_b32 s34, 0x800000
    s_mov_b32 s35, 0x20000
    s_lshl_b32 s54, s45, 18
    buffer_load_dword v177, v3, s[32:35], s54 offen nt
    s_lshl_b32 s54, s2, 20
    s_add_u32 s32, s8, s54
    s_addc_u32 s33, s9, 0
    s_mov_b32 s34, 0x100000
    s_mov_b32 s35, 0x20000
    buffer_load_dword v178, v3, s[32:35], 0 offen nt
    s_mov_b64 exec, -1
L_a_notouch:
    s_mov_b64 exec, 1
    v_mov_b32 v3, 1
    ds_add_rtn_u32 v3, v2, v3 offset:8
    s_waitcnt lgkmcnt(0)
    v_readfirstlane_b32 s56, v3
    s_mov_b64 exec, -1
    s_mov_b32 s57, 0
L_w_177:
    ds_read_b32 v3, v2 offset:8
    s_waitcnt lgkmcnt(0)
    v_readfirstlane_b32 s56, v3
    s_cmp_ge_u32 s56, 4
    s_cbranch_scc1 L_wd_178
    s_add_u32 s57, s57, 1
    s_cmp_lt_u32 s57, 0x100000
    s_cbranch_scc1 L_w_177
L_wd_178:
    v_add_u32 v15, 0x18000, v9
    ds_read_b64_tr_b16 v[96:97], v15 offset:0
    ds_read_b64_tr_b16 v[98:99], v15 offset:1024
    ds_read_b64_tr_b16 v[100:101], v15 offset:8192
    ds_read_b64_tr_b16 v[102:103], v15 offset:9216
    ds_read_b64_tr_b16 v[104:105], v15 offset:16384
    ds_read_b64_tr_b16 v[106:107], v15 offset:17408
    ds_read_b64_tr_b16 v[108:109], v15 offset:24576
    ds_read_b64_tr_b16 v[110:111], v15 offset:25600
    s_waitcnt lgkmcnt(6)
    ds_read_b64_tr_b16 v[112:113], v15 offset:32
    ds_read_b64_tr_b16 v[114:115], v15 offset:1056
    ds_read_b64_tr_b16 v[116:117], v15 offset:8224
    ds_read_b64_tr_b16 v[118:119], v15 offset:9248
    ds_read_b64_tr_b16 v[120:121], v15 offset:16416
    ds_read_b64_tr_b16 v[122:123], v15 offset:17440
    ds_read_b64_tr_b16 v[124:125], v15 offset:24608
    ds_read_b64_tr_b16 v[126:127], v15 offset:25632
    v_lshrrev_b32 v3, 5, v1
    v_lshlrev_b32 v14, 8, v3
    v_lshl_add_u32 v14, v7, 5, v14
    v_and_b32 v3, 1, v5
    v_lshl_add_u32 v14, v3, 4, v14
    v_add_u32 v14, 0x21900, v14
    s_waitcnt lgkmcnt(0)
    v_cndmask_b32 v108, v108, 0, s[100:101]
    v_cndmask_b32 v109, v109, 0, s[100:101]
    v_cndmask_b32 v110, v110, 0, s[100:101]
    v_cndmask_b32 v111, v111, 0, s[100:101]
    v_cndmask_b32 v124, v124, 0, s[100:101]
    v_cndmask_b32 v125, v125, 0, s[100:101]
    v_cndmask_b32 v126, v126, 0, s[100:101]
    v_cndmask_b32 v127, v127, 0, s[100:101]
    s_cmp_lg_u32 s3, 0
    s_cbranch_scc1 L_a_hw
    s_cmp_ge_u32 s46, 224
    s_cbranch_scc1 L_a_s15done
    s_mov_b32 s57, 0
L_w_179:
    ds_read_b32 v3, v2 offset:32
    s_waitcnt lgkmcnt(0)
    v_readfirstlane_b32 s56, v3
    s_cmp_ge_u32 s56, 2
    s_cbranch_scc1 L_wd_180
    s_sleep 8
    s_add_u32 s57, s57, 1
    s_cmp_lt_u32 s57, 0x100000
    s_cbranch_scc1 L_w_179
L_wd_180:
    s_lshl_b32 s54, s47, 14
    s_lshl_b32 s55, s48, 10
    s_add_u32 s54, s54, s55
    s_add_u32 s54, s54, 0x400000
    s_add_u32 s55, s48, 1
    s_and_b32 s55, s55, 3
    s_lshl_b32 s55, s55, 12
    s_add_u32 s55, s55, s54
    s_add_u32 s50, s48, 2
    s_and_b32 s50, s50, 3
    s_lshl_b32 s50, s50, 12
    s_add_u32 s50, s50, s54
    s_add_u32 s51, s48, 3
    s_and_b32 s51, s51, 3
    s_lshl_b32 s51, s51, 12
    s_add_u32 s51, s51, s54
    v_add_u32 v13, 0x20000, v10
    s_mov_b32 s57, 0
L_gpoll:
    ds_read_b128 v[32:35], v13
    buffer_load_dwordx4 v[36:39], v10, s[36:39], s55 offen nt sc1
    buffer_load_dwordx4 v[40:43], v10, s[36:39], s50 offen nt sc1
    buffer_load_dwordx4 v[44:47], v10, s[36:39], s51 offen nt sc1
    s_waitcnt lgkmcnt(0)
    s_add_u32 s57, s57, 1
    s_waitcnt vmcnt(0)
    v_xor_b32 v32, v32, v20
    v_xor_b32 v33, v33, v21
    v_xor_b32 v34, v34, v22
    v_xor_b32 v35, v35, v23
    v_xor_b32 v36, v36, v20
    v_xor_b32 v37, v37, v21
    v_xor_b32 v38, v38, v22
    v_xor_b32 v39, v39, v23
    v_xor_b32 v40, v40, v20
    v_xor_b32 v41, v41, v21
    v_xor_b32 v42, v42, v22
    v_xor_b32 v43, v43, v23
    v_xor_b32 v44, v44, v20
    v_xor_b32 v45, v45, v21
    v_xor_b32 v46, v46, v22
    v_xor_b32 v47, v47, v23
    v_or3_b32 v3, v32, v33, v34
    v_or3_b32 v4, v35, v36, v37
    v_or3_b32 v3, v3, v38, v39
    v_or3_b32 v4, v4, v40, v41
    v_or3_b32 v3, v3, v42, v43
    v_or3_b32 v4, v4, v44, v45
    v_or3_b32 v3, v3, v46, v47
    v_or_b32 v3, v3, v4
    v_and_b32 v3, 0xff, v3
    v_cmp_ne_u32 vcc, 0, v3
    s_cbranch_vccz L_gpoll_go
    s_sleep 32
    s_cmp_lt_u32 s57, 0x10000
    s_cbranch_scc1 L_gpoll
L_gpoll_go:
    v_lshlrev_b32 v3, 6, v7
    v_lshl_add_u32 v3, v5, 4, v3
    s_lshl_b32 s54, s46, 9
    s_add_u32 s54, s54, 0x520000
    v_add_f32 v32, v32, v36
    v_add_f32 v33, v33, v37
    v_add_f32 v34, v34, v38
    v_add_f32 v35, v35, v39
    v_add_f32 v32, v32, v40
    v_add_f32 v33, v33, v41
    v_add_f32 v34, v34, v42
    v_add_f32 v35, v35, v43
    v_add_f32 v32, v32, v44
    v_add_f32 v33, v33, v45
    v_add_f32 v34, v34, v46
    v_add_f32 v35, v35, v47
    v_cvt_pk_bf16_f32 v32, v32, v32
    v_and_b32 v32, 0xffff0000, v32
    v_cvt_pk_bf16_f32 v33, v33, v33
    v_and_b32 v33, 0xffff0000, v33
    v_cvt_pk_bf16_f32 v34, v34, v34
    v_and_b32 v34, 0xffff0000, v34
    v_cvt_pk_bf16_f32 v35, v35, v35
    v_and_b32 v35, 0xffff0000, v35
    s_nop 1
    v_mul_f32_dpp v36, v32, v32 row_ror:8 row_mask:0xf bank_mask:0xf
    v_mul_f32_dpp v37, v33, v33 row_ror:8 row_mask:0xf bank_mask:0xf
    v_mul_f32_dpp v38, v34, v34 row_ror:8 row_mask:0xf bank_mask:0xf
    v_mul_f32_dpp v39, v35, v35 row_ror:8 row_mask:0xf bank_mask:0xf
    v_cvt_pk_bf16_f32 v36, v36, v36
    v_and_b32 v36, 0xffff0000, v36
    v_cvt_pk_bf16_f32 v37, v37, v37
    v_and_b32 v37, 0xffff0000, v37
    v_cvt_pk_bf16_f32 v38, v38, v38
    v_and_b32 v38, 0xffff0000, v38
    v_cvt_pk_bf16_f32 v39, v39, v39
    v_and_b32 v39, 0xffff0000, v39
    v_or_b32 v36, v36, v64
    v_or_b32 v37, v37, v65
    v_or_b32 v38, v38, v66
    v_or_b32 v39, v39, v67
    s_not_b64 exec, s[58:59]
    buffer_store_dwordx4 v[36:39], v3, s[36:39], s54 offen nt sc1
    s_mov_b64 exec, -1
L_a_s15done:
    s_mov_b32 s57, 0
L_w_181:
    ds_read_b32 v3, v2 offset:32
    s_waitcnt lgkmcnt(0)
    v_readfirstlane_b32 s56, v3
    s_cmp_ge_u32 s56, 4
    s_cbranch_scc1 L_wd_182
    s_sleep 8
    s_add_u32 s57, s57, 1
    s_cmp_lt_u32 s57, 0x100000
    s_cbranch_scc1 L_w_181
L_wd_182:
    s_mul_i32 s54, s45, 3584
    s_add_u32 s54, s54, 0x520000
    v_and_b32 v13, 0x1ff, v10
    s_mov_b32 s57, 0
L_hpoll:
    buffer_load_dwordx4 v[32:35], v10, s[36:39], s54 offen offset:0 nt sc1
    buffer_load_dwordx4 v[36:39], v10, s[36:39], s54 offen offset:1024 nt sc1
    buffer_load_dwordx4 v[40:43], v10, s[36:39], s54 offen offset:2048 nt sc1
    buffer_load_dwordx4 v[44:47], v13, s[36:39], s54 offen offset:3072 nt sc1
    s_add_u32 s57, s57, 1
    s_waitcnt vmcnt(0)
    v_xor_b32 v32, v32, v64
    v_xor_b32 v33, v33, v65
    v_xor_b32 v34, v34, v66
    v_xor_b32 v35, v35, v67
    v_xor_b32 v36, v36, v64
    v_xor_b32 v37, v37, v65
    v_xor_b32 v38, v38, v66
    v_xor_b32 v39, v39, v67
    v_xor_b32 v40, v40, v64
    v_xor_b32 v41, v41, v65
    v_xor_b32 v42, v42, v66
    v_xor_b32 v43, v43, v67
    v_xor_b32 v44, v44, v64
    v_xor_b32 v45, v45, v65
    v_xor_b32 v46, v46, v66
    v_xor_b32 v47, v47, v67
    v_or3_b32 v3, v32, v33, v34
    v_or3_b32 v4, v35, v36, v37
    v_or3_b32 v3, v3, v38, v39
    v_or3_b32 v4, v4, v40, v41
    v_or3_b32 v3, v3, v42, v43
    v_or3_b32 v4, v4, v44, v45
    v_or3_b32 v3, v3, v46, v47
    v_or_b32 v3, v3, v4
    v_and_b32 v3, 0xfff, v3
    v_cmp_ne_u32 vcc, 0, v3
    s_cbranch_vccz L_hpoll_go
    s_sleep 32
    s_cmp_lt_u32 s57, 0x10000
    s_cbranch_scc1 L_hpoll
L_hpoll_go:
    v_lshlrev_b32 v3, 3, v1
    v_add_u32 v3, 0x21900, v3
    v_cvt_pk_bf16_f32 v32, v32, v33
    v_cvt_pk_bf16_f32 v33, v34, v35
    ds_write_b64 v3, v[32:33] offset:0
    v_cvt_pk_bf16_f32 v36, v36, v37
    v_cvt_pk_bf16_f32 v37, v38, v39
    ds_write_b64 v3, v[36:37] offset:512
    v_cvt_pk_bf16_f32 v40, v40, v41
    v_cvt_pk_bf16_f32 v41, v42, v43
    ds_write_b64 v3, v[40:41] offset:1024
    v_cvt_pk_bf16_f32 v44, v44, v45
    v_cvt_pk_bf16_f32 v45, v46, v47
    ds_write_b64 v3, v[44:45] offset:1536
L_a_hdone:
    s_mov_b64 exec, 1
    v_mov_b32 v3, 1
    ds_add_rtn_u32 v3, v2, v3 offset:12
    s_waitcnt lgkmcnt(0)
    v_readfirstlane_b32 s56, v3
    s_mov_b64 exec, -1
L_a_hw:
    s_mov_b32 s57, 0
L_w_183:
    ds_read_b32 v3, v2 offset:12
    s_waitcnt lgkmcnt(0)
    v_readfirstlane_b32 s56, v3
    s_cmp_ge_u32 s56, 1
    s_cbranch_scc1 L_wd_184
    s_sleep 8
    s_add_u32 s57, s57, 1
    s_cmp_lt_u32 s57, 0x100000
    s_cbranch_scc1 L_w_183
L_wd_184:
    ds_read_b128 v[80:83], v14 offset:0
    ds_read_b128 v[84:87], v14 offset:512
    ds_read_b128 v[88:91], v14 offset:1024
    ds_read_b128 v[92:95], v14 offset:1536
    s_waitcnt lgkmcnt(0)
    v_mfma_f32_16x16x32_bf16 v[72:75], v[96:99], v[80:83], 0
    v_mfma_f32_16x16x32_bf16 v[76:79], v[112:115], v[80:83], 0
    v_mfma_f32_16x16x32_bf16 v[72:75], v[100:103], v[84:87], v[72:75]
    v_mfma_f32_16x16x32_bf16 v[76:79], v[116:119], v[84:87], v[76:79]
    v_mfma_f32_16x16x32_bf16 v[72:75], v[104:107], v[88:91], v[72:75]
    v_mfma_f32_16x16x32_bf16 v[76:79], v[120:123], v[88:91], v[76:79]
    v_mfma_f32_16x16x32_bf16 v[72:75], v[108:111], v[92:95], v[72:75]
    v_mfma_f32_16x16x32_bf16 v[76:79], v[124:127], v[92:95], v[76:79]
    s_cmp_eq_u32 s3, 1
    s_cbranch_scc1 L_a_stats
    s_cmp_eq_u32 s3, 2
    s_cbranch_scc1 L_a_ctl
    s_cmp_lg_u32 s3, 0
    s_cbranch_scc1 L_a_b2
    s_lshl_b32 s54, s2, 6
    v_lshlrev_b32 v3, 3, v7
    buffer_load_dwordx2 v[32:33], v3, s[28:31], s54 offen
    v_lshlrev_b32 v3, 4, v7
    v_add_u32 v3, 0x22920, v3
    s_waitcnt vmcnt(0)
    v_lshlrev_b32 v36, 16, v32
    v_and_b32 v37, 0xffff0000, v32
    v_lshlrev_b32 v38, 16, v33
    v_and_b32 v39, 0xffff0000, v33
    ds_write_b128 v3, v[36:39]
    s_branch L_a_b2
L_a_ctl:
    s_bfe_u32 s55, s2, 0x20006
    s_lshl_b32 s55, s55, 13
    s_add_u32 s55, s55, 0x540000
    s_mov_b32 s50, 0x0
    s_mov_b32 s51, 0x54322110
    s_mov_b32 s57, 0
    s_mov_b32 s53, 0
    v_mov_b32 v4, 0
    s_mov_b64 exec, 1
L_ctl_185:
    s_cmp_ge_u32 s57, 0x100000
    s_cbranch_scc1 L_ctl_done
    ds_read_b32 v3, v2 offset:32
    s_add_u32 s57, s57, 1
    s_waitcnt lgkmcnt(0)
    v_readfirstlane_b32 s56, v3
    s_cmp_ge_u32 s56, 7
    s_cbranch_scc1 L_ctl_go_186
    s_sleep 4
    s_branch L_ctl_185
L_ctl_go_186:
    s_add_u32 s54, s55, 0x0
    v_mov_b32 v3, 1
    buffer_atomic_add v3, v4, s[36:39], s54 offen sc0 sc1 nt
    s_waitcnt vmcnt(0)
    v_readfirstlane_b32 s54, v3
    s_and_b32 s54, s54, 60
    s_lshr_b64 s[62:63], s[50:51], s54
    s_and_b32 s54, s62, 15
    s_add_u32 s56, s54, 8
    s_cmp_eq_u32 s54, 0
    s_cselect_b32 s56, 0, s56
    v_mov_b32 v3, s56
    ds_write_b32 v2, v3 offset:20
L_ctl_187:
    s_cmp_ge_u32 s57, 0x100000
    s_cbranch_scc1 L_ctl_done
    ds_read_b32 v3, v2 offset:32
    s_add_u32 s57, s57, 1
    s_waitcnt lgkmcnt(0)
    v_readfirstlane_b32 s56, v3
    s_cmp_ge_u32 s56, 16
    s_cbranch_scc1 L_ctl_go_188
    s_sleep 4
    s_branch L_ctl_187
L_ctl_go_188:
    s_add_u32 s54, s55, 0x100
    v_mov_b32 v3, 1
    buffer_atomic_add v3, v4, s[36:39], s54 offen sc0 sc1 nt
    s_waitcnt vmcnt(0)
    v_readfirstlane_b32 s54, v3
    s_and_b32 s54, s54, 60
    s_lshr_b64 s[62:63], s[50:51], s54
    s_and_b32 s54, s62, 15
    s_add_u32 s56, s54, 17
    s_cmp_eq_u32 s54, 0
    s_cselect_b32 s56, 0, s56
    v_mov_b32 v3, s56
    ds_write_b32 v2, v3 offset:20
L_ctl_189:
    s_cmp_ge_u32 s57, 0x100000
    s_cbranch_scc1 L_ctl_done
    ds_read_b32 v3, v2 offset:32
    s_add_u32 s57, s57, 1
    s_waitcnt lgkmcnt(0)
    v_readfirstlane_b32 s56, v3
    s_cmp_ge_u32 s56, 25
    s_cbranch_scc1 L_ctl_go_190
    s_sleep 4
    s_branch L_ctl_189
L_ctl_go_190:
    s_add_u32 s54, s55, 0x200
    v_mov_b32 v3, 1
    buffer_atomic_add v3, v4, s[36:39], s54 offen sc0 sc1 nt
    s_waitcnt vmcnt(0)
    v_readfirstlane_b32 s54, v3
    s_and_b32 s54, s54, 60
    s_lshr_b64 s[62:63], s[50:51], s54
    s_and_b32 s54, s62, 15
    v_readfirstlane_b32 s52, v3
    s_mov_b32 s50, 0x55443210
    s_mov_b32 s51, 0x76555555
    s_and_b32 s52, s52, 60
    s_lshr_b64 s[62:63], s[50:51], s52
    s_and_b32 s52, s62, 15
    v_mov_b32 v3, s52
    ds_max_u32 v2, v3 offset:24
    s_nop 0
    s_add_u32 s56, s54, 26
    s_cmp_eq_u32 s54, 0
    s_cselect_b32 s56, 0, s56
    v_mov_b32 v3, s56
    ds_write_b32 v2, v3 offset:20
L_ctl_done:
    s_mov_b64 exec, -1
    s_branch L_a_b2
L_a_stats:
    s_mov_b32 s57, 0
L_w_191:
    ds_read_b32 v3, v2 offset:28
    s_waitcnt lgkmcnt(0)
    v_readfirstlane_b32 s56, v3
    s_cmp_ge_u32 s56, 4
    s_cbranch_scc1 L_wd_192
    s_sleep 32
    s_add_u32 s57, s57, 1
    s_cmp_lt_u32 s57, 0x100000
    s_cbranch_scc1 L_w_191
L_wd_192:
    v_mov_b32 v3, 0x22900
    ds_read_b128 v[32:35], v3
    ds_read_b128 v[128:131], v10 offset:0
    ds_read_b128 v[132:135], v10 offset:1024
    ds_read_b128 v[136:139], v10 offset:2048
    ds_read_b128 v[140:143], v10 offset:3072
    ds_read_b128 v[144:147], v10 offset:4096
    ds_read_b128 v[148:151], v10 offset:5120
    ds_read_b128 v[152:155], v10 offset:6144
    ds_read_b128 v[156:159], v10 offset:7168
    s_waitcnt lgkmcnt(0)
    ds_read_b128 v[160:163], v10 offset:8192
    ds_read_b128 v[164:167], v10 offset:9216
    ds_read_b128 v[168:171], v10 offset:10240
    ds_read_b128 v[172:175], v10 offset:11264
    ds_read_b128 v[176:179], v10 offset:12288
    ds_read_b128 v[180:183], v10 offset:13312
    ds_read_b128 v[184:187], v10 offset:14336
    ds_read_b128 v[188:191], v10 offset:15360
    s_waitcnt lgkmcnt(0)
    v_max3_f32 v3, v32, v33, v34
    v_max_f32 v3, v3, v35
    v_mul_f32 v3, 0xbfb8aa3b, v3
    s_mov_b32 s53, 0x3fb8aa3b
    v_fma_f32 v128, v128, s53, v3
    v_fma_f32 v129, v129, s53, v3
    v_fma_f32 v130, v130, s53, v3
    v_fma_f32 v131, v131, s53, v3
    v_fma_f32 v132, v132, s53, v3
    v_fma_f32 v133, v133, s53, v3
    v_fma_f32 v134, v134, s53, v3
    v_fma_f32 v135, v135, s53, v3
    v_fma_f32 v136, v136, s53, v3
    v_fma_f32 v137, v137, s53, v3
    v_fma_f32 v138, v138, s53, v3
    v_fma_f32 v139, v139, s53, v3
    v_fma_f32 v140, v140, s53, v3
    v_fma_f32 v141, v141, s53, v3
    v_fma_f32 v142, v142, s53, v3
    v_fma_f32 v143, v143, s53, v3
    v_fma_f32 v144, v144, s53, v3
    v_fma_f32 v145, v145, s53, v3
    v_fma_f32 v146, v146, s53, v3
    v_fma_f32 v147, v147, s53, v3
    v_fma_f32 v148, v148, s53, v3
    v_fma_f32 v149, v149, s53, v3
    v_fma_f32 v150, v150, s53, v3
    v_fma_f32 v151, v151, s53, v3
    v_fma_f32 v152, v152, s53, v3
    v_fma_f32 v153, v153, s53, v3
    v_fma_f32 v154, v154, s53, v3
    v_fma_f32 v155, v155, s53, v3
    v_fma_f32 v156, v156, s53, v3
    v_fma_f32 v157, v157, s53, v3
    v_fma_f32 v158, v158, s53, v3
    v_fma_f32 v159, v159, s53, v3
    v_fma_f32 v160, v160, s53, v3
    v_fma_f32 v161, v161, s53, v3
    v_fma_f32 v162, v162, s53, v3
    v_fma_f32 v163, v163, s53, v3
    v_fma_f32 v164, v164, s53, v3
    v_fma_f32 v165, v165, s53, v3
    v_fma_f32 v166, v166, s53, v3
    v_fma_f32 v167, v167, s53, v3
    v_fma_f32 v168, v168, s53, v3
    v_fma_f32 v169, v169, s53, v3
    v_fma_f32 v170, v170, s53, v3
    v_fma_f32 v171, v171, s53, v3
    v_fma_f32 v172, v172, s53, v3
    v_fma_f32 v173, v173, s53, v3
    v_fma_f32 v174, v174, s53, v3
    v_fma_f32 v175, v175, s53, v3
    v_fma_f32 v176, v176, s53, v3
    v_fma_f32 v177, v177, s53, v3
    v_fma_f32 v178, v178, s53, v3
    v_fma_f32 v179, v179, s53, v3
    v_fma_f32 v180, v180, s53, v3
    v_fma_f32 v181, v181, s53, v3
    v_fma_f32 v182, v182, s53, v3
    v_fma_f32 v183, v183, s53, v3
    v_fma_f32 v184, v184, s53, v3
    v_fma_f32 v185, v185, s53, v3
    v_fma_f32 v186, v186, s53, v3
    v_fma_f32 v187, v187, s53, v3
    v_fma_f32 v188, v188, s53, v3
    v_fma_f32 v189, v189, s53, v3
    v_fma_f32 v190, v190, s53, v3
    v_fma_f32 v191, v191, s53, v3
    v_exp_f32 v128, v128
    v_exp_f32 v129, v129
    v_exp_f32 v130, v130
    v_exp_f32 v131, v131
    v_exp_f32 v132, v132
    v_exp_f32 v133, v133
    v_exp_f32 v134, v134
    v_exp_f32 v135, v135
    v_exp_f32 v136, v136
    v_exp_f32 v137, v137
    v_exp_f32 v138, v138
    v_exp_f32 v139, v139
    v_exp_f32 v140, v140
    v_exp_f32 v141, v141
    v_exp_f32 v142, v142
    v_exp_f32 v143, v143
    v_exp_f32 v144, v144
    v_exp_f32 v145, v145
    v_exp_f32 v146, v146
    v_exp_f32 v147, v147
    v_exp_f32 v148, v148
    v_exp_f32 v149, v149
    v_exp_f32 v150, v150
    v_exp_f32 v151, v151
    v_exp_f32 v152, v152
    v_exp_f32 v153, v153
    v_exp_f32 v154, v154
    v_exp_f32 v155, v155
    v_exp_f32 v156, v156
    v_exp_f32 v157, v157
    v_exp_f32 v158, v158
    v_exp_f32 v159, v159
    v_exp_f32 v160, v160
    v_exp_f32 v161, v161
    v_exp_f32 v162, v162
    v_exp_f32 v163, v163
    v_exp_f32 v164, v164
    v_exp_f32 v165, v165
    v_exp_f32 v166, v166
    v_exp_f32 v167, v167
    v_exp_f32 v168, v168
    v_exp_f32 v169, v169
    v_exp_f32 v170, v170
    v_exp_f32 v171, v171
    v_exp_f32 v172, v172
    v_exp_f32 v173, v173
    v_exp_f32 v174, v174
    v_exp_f32 v175, v175
    v_exp_f32 v176, v176
    v_exp_f32 v177, v177
    v_exp_f32 v178, v178
    v_exp_f32 v179, v179
    v_exp_f32 v180, v180
    v_exp_f32 v181, v181
    v_exp_f32 v182, v182
    v_exp_f32 v183, v183
    v_exp_f32 v184, v184
    v_exp_f32 v185, v185
    v_exp_f32 v186, v186
    v_exp_f32 v187, v187
    v_exp_f32 v188, v188
    v_exp_f32 v189, v189
    v_exp_f32 v190, v190
    v_exp_f32 v191, v191
    v_fma_f32 v32, v32, s53, v3
    v_fma_f32 v33, v33, s53, v3
    v_fma_f32 v34, v34, s53, v3
    v_fma_f32 v35, v35, s53, v3
    v_exp_f32 v32, v32
    v_exp_f32 v33, v33
    v_exp_f32 v34, v34
    v_exp_f32 v35, v35
    v_pk_add_f32 v[128:129], v[128:129], v[160:161]
    v_pk_add_f32 v[130:131], v[130:131], v[162:163]
    v_pk_add_f32 v[132:133], v[132:133], v[164:165]
    v_pk_add_f32 v[134:135], v[134:135], v[166:167]
    v_pk_add_f32 v[136:137], v[136:137], v[168:169]
    v_pk_add_f32 v[138:139], v[138:139], v[170:171]
    v_pk_add_f32 v[140:141], v[140:141], v[172:173]
    v_pk_add_f32 v[142:143], v[142:143], v[174:175]
    v_pk_add_f32 v[144:145], v[144:145], v[176:177]
    v_pk_add_f32 v[146:147], v[146:147], v[178:179]
    v_pk_add_f32 v[148:149], v[148:149], v[180:181]
    v_pk_add_f32 v[150:151], v[150:151], v[182:183]
    v_pk_add_f32 v[152:153], v[152:153], v[184:185]
    v_pk_add_f32 v[154:155], v[154:155], v[186:187]
    v_pk_add_f32 v[156:157], v[156:157], v[188:189]
    v_pk_add_f32 v[158:159], v[158:159], v[190:191]
    v_pk_add_f32 v[128:129], v[128:129], v[144:145]
    v_pk_add_f32 v[130:131], v[130:131], v[146:147]
    v_pk_add_f32 v[132:133], v[132:133], v[148:149]
    v_pk_add_f32 v[134:135], v[134:135], v[150:151]
    v_pk_add_f32 v[136:137], v[136:137], v[152:153]
    v_pk_add_f32 v[138:139], v[138:139], v[154:155]
    v_pk_add_f32 v[140:141], v[140:141], v[156:157]
    v_pk_add_f32 v[142:143], v[142:143], v[158:159]
    v_pk_add_f32 v[128:129], v[128:129], v[136:137]
    v_pk_add_f32 v[130:131], v[130:131], v[138:139]
    v_pk_add_f32 v[132:133], v[132:133], v[140:141]
    v_pk_add_f32 v[134:135], v[134:135], v[142:143]
    v_pk_add_f32 v[128:129], v[128:129], v[132:133]
    v_pk_add_f32 v[130:131], v[130:131], v[134:135]
    v_pk_add_f32 v[128:129], v[128:129], v[130:131]
    v_add_f32 v128, v128, v129
    s_nop 1
    v_add_f32_dpp v128, v128, v128 row_ror:8 row_mask:0xf bank_mask:0xf
    s_nop 1
    v_add_f32_dpp v128, v128, v128 row_ror:4 row_mask:0xf bank_mask:0xf
    s_nop 1
    v_add_f32_dpp v128, v128, v128 row_ror:2 row_mask:0xf bank_mask:0xf
    s_nop 1
    v_add_f32_dpp v128, v128, v128 row_ror:1 row_mask:0xf bank_mask:0xf
    v_mov_b32 v3, v128
    s_nop 1
    v_permlane16_swap_b32 v128, v3
    s_nop 0
    v_add_f32 v128, v128, v3
    v_mov_b32 v3, v128
    s_nop 1
    v_permlane32_swap_b32 v128, v3
    s_nop 0
    v_add_f32 v128, v128, v3
    v_rcp_f32 v128, v128
    s_nop 0
    v_mul_f32 v32, v32, v128
    v_mul_f32 v33, v33, v128
    v_mul_f32 v34, v34, v128
    v_mul_f32 v35, v35, v128
    v_mov_b32 v3, 0x22910
    ds_write_b128 v3, v[32:35]
L_a_b2:
    v_mul_u32_u24 v14, 272, v7
    v_lshl_add_u32 v14, v5, 4, v14
    v_add_u32 v14, 0x20800, v14
    s_mov_b32 s57, 0
L_w_193:
    ds_read_b32 v3, v2 offset:32
    s_waitcnt lgkmcnt(0)
    v_readfirstlane_b32 s56, v3
    s_cmp_ge_u32 s56, 28
    s_cbranch_scc1 L_wd_194
    s_sleep 8
    s_add_u32 s57, s57, 1
    s_cmp_lt_u32 s57, 0x100000
    s_cbranch_scc1 L_w_193
L_wd_194:
    s_mov_b32 s57, 0
L_w_195:
    ds_read_b32 v3, v2 offset:4
    s_waitcnt lgkmcnt(0)
    v_readfirstlane_b32 s56, v3
    s_cmp_ge_u32 s56, 256
    s_cbranch_scc1 L_wd_196
    s_sleep 1
    s_add_u32 s57, s57, 1
    s_cmp_lt_u32 s57, 0x100000
    s_cbranch_scc1 L_w_195
L_wd_196:
    s_lshl_b32 s50, s45, 18
    s_lshl_b32 s51, s44, 8
    s_add_u32 s50, s50, s51
    s_sub_u32 s51, 0x800000, s50
    s_add_u32 s32, s12, s50
    s_addc_u32 s33, s13, 0
    s_mov_b32 s34, s51
    s_mov_b32 s35, 0x20000
    v_lshlrev_b32 v3, 11, v5
    v_lshl_add_u32 v3, v6, 4, v3
    s_lshl_b32 s54, s3, 13
    s_add_u32 m0, s54, 0x8000
    s_lshl_b32 s55, s3, 16
    s_nop 0
    buffer_load_dwordx4 v3, s[32:35], s55 offen nt lds
    s_add_u32 m0, m0, 0x400
    s_add_u32 s55, s55, 0x2000
    s_nop 0
    buffer_load_dwordx4 v3, s[32:35], s55 offen nt lds
    s_add_u32 m0, m0, 0x400
    s_add_u32 s55, s55, 0x2000
    s_nop 0
    buffer_load_dwordx4 v3, s[32:35], s55 offen nt lds
    s_add_u32 m0, m0, 0x400
    s_add_u32 s55, s55, 0x2000
    s_nop 0
    buffer_load_dwordx4 v3, s[32:35], s55 offen nt lds
    s_add_u32 m0, m0, 0x400
    s_add_u32 s55, s55, 0x2000
    s_nop 0
    buffer_load_dwordx4 v3, s[32:35], s55 offen nt lds
    s_add_u32 m0, m0, 0x400
    s_add_u32 s55, s55, 0x2000
    s_nop 0
    buffer_load_dwordx4 v3, s[32:35], s55 offen nt lds
    s_add_u32 m0, m0, 0x400
    s_add_u32 s55, s55, 0x2000
    s_nop 0
    buffer_load_dwordx4 v3, s[32:35], s55 offen nt lds
    s_add_u32 m0, m0, 0x400
    s_add_u32 s55, s55, 0x2000
    s_nop 0
    buffer_load_dwordx4 v3, s[32:35], s55 offen nt lds
    s_waitcnt lgkmcnt(0)
    s_barrier
    s_waitcnt vmcnt(0)
    s_mov_b64 exec, 1
    v_mov_b32 v3, 1
    ds_add_rtn_u32 v3, v2, v3 offset:16
    s_waitcnt lgkmcnt(0)
    v_readfirstlane_b32 s56, v3
    s_mov_b64 exec, -1
    s_mov_b32 s57, 0
L_w_197:
    ds_read_b32 v3, v2 offset:16
    s_waitcnt lgkmcnt(0)
    v_readfirstlane_b32 s56, v3
    s_cmp_ge_u32 s56, 4
    s_cbranch_scc1 L_wd_198
    s_add_u32 s57, s57, 1
    s_cmp_lt_u32 s57, 0x100000
    s_cbranch_scc1 L_w_197
L_wd_198:
    ds_read_b64_tr_b16 v[96:97], v9 offset:32768
    ds_read_b64_tr_b16 v[98:99], v9 offset:33792
    ds_read_b64_tr_b16 v[100:101], v9 offset:40960
    ds_read_b64_tr_b16 v[102:103], v9 offset:41984
    ds_read_b64_tr_b16 v[104:105], v9 offset:49152
    ds_read_b64_tr_b16 v[106:107], v9 offset:50176
    ds_read_b64_tr_b16 v[108:109], v9 offset:57344
    ds_read_b64_tr_b16 v[110:111], v9 offset:58368
    s_waitcnt lgkmcnt(6)
    ds_read_b64_tr_b16 v[112:113], v9 offset:32800
    ds_read_b64_tr_b16 v[114:115], v9 offset:33824
    ds_read_b64_tr_b16 v[116:117], v9 offset:40992
    ds_read_b64_tr_b16 v[118:119], v9 offset:42016
    ds_read_b64_tr_b16 v[120:121], v9 offset:49184
    ds_read_b64_tr_b16 v[122:123], v9 offset:50208
    ds_read_b64_tr_b16 v[124:125], v9 offset:57376
    ds_read_b64_tr_b16 v[126:127], v9 offset:58400
    s_barrier
    ds_read_b128 v[80:83], v14 offset:0
    ds_read_b128 v[84:87], v14 offset:64
    ds_read_b128 v[88:91], v14 offset:128
    ds_read_b128 v[92:95], v14 offset:192
    s_waitcnt lgkmcnt(0)
    v_mfma_f32_16x16x32_bf16 v[72:75], v[96:99], v[80:83], v[72:75]
    v_mfma_f32_16x16x32_bf16 v[76:79], v[112:115], v[80:83], v[76:79]
    v_mfma_f32_16x16x32_bf16 v[72:75], v[100:103], v[84:87], v[72:75]
    v_mfma_f32_16x16x32_bf16 v[76:79], v[116:119], v[84:87], v[76:79]
    v_mfma_f32_16x16x32_bf16 v[72:75], v[104:107], v[88:91], v[72:75]
    v_mfma_f32_16x16x32_bf16 v[76:79], v[120:123], v[88:91], v[76:79]
    v_mfma_f32_16x16x32_bf16 v[72:75], v[108:111], v[92:95], v[72:75]
    v_mfma_f32_16x16x32_bf16 v[76:79], v[124:127], v[92:95], v[76:79]
    s_nop 7
    v_cndmask_b32 v72, v72, v76, s[58:59]
    v_cndmask_b32 v73, v73, v77, s[58:59]
    v_cndmask_b32 v74, v74, v78, s[58:59]
    v_cndmask_b32 v75, v75, v79, s[58:59]
    v_add_u32 v72, 0x800, v72
    v_add_u32 v73, 0x800, v73
    v_add_u32 v74, 0x800, v74
    v_add_u32 v75, 0x800, v75
    v_and_or_b32 v72, v72, s49, v64
    v_and_or_b32 v73, v73, s49, v65
    v_and_or_b32 v74, v74, s49, v66
    v_and_or_b32 v75, v75, s49, v67
    buffer_store_dwordx4 v[72:75], v8, s[36:39], s61 offen sc1
L_end:
    s_endpgm
.section .rodata,"a"
.p2align 6
.amdhsa_kernel parallel_sum__mha_block_cached__glu_gated_bilinear__decode_kernel
  .amdhsa_next_free_vgpr 256
  .amdhsa_next_free_sgpr 102
  .amdhsa_accum_offset 256
  .amdhsa_group_segment_fixed_size 0
  .amdhsa_kernarg_size 96
  .amdhsa_user_sgpr_count 2
  .amdhsa_user_sgpr_kernarg_segment_ptr 1
  .amdhsa_system_sgpr_workgroup_id_x 1
.end_amdhsa_kernel
```
